```python
import torch

def _softmax(x, axis=-1):
    return torch.softmax(x, dim=axis)
def _gelu(x):
    return torch.nn.functional.gelu(x, approximate="tanh")
def _silu(x):
    return torch.nn.functional.silu(x)
def _sigmoid(x):
    return torch.sigmoid(x)
def _layernorm(x, axis=-1, eps=1e-5):
    m = x.mean(dim=axis, keepdim=True)
    v = x.var(dim=axis, keepdim=True, unbiased=False)
    return (x - m) / torch.sqrt(v + eps)
def _scatter_add(tgt, idx, src, axis=0):
    return tgt.clone().index_add_(axis, idx, src)
def _segment_sum(src, seg, n):
    out = torch.zeros((n,) + src.shape[1:], dtype=src.dtype)
    return out.index_add_(0, seg, src)
def _pad(x, pw):
    flat = tuple(v for pair in reversed(pw) for v in pair)
    return torch.nn.functional.pad(x, flat)

kernel_name = 'standalone__mha_block_cached__near_ridge'

def setup_inputs():

    _w = (lambda a: (lambda t: t.to(torch.bfloat16) if t.is_floating_point() else t)(torch.as_tensor(a)))
    B, Sq, D = 16, 256, 512
    H, Sk, Dh = 32, 1024, 128
    return {
        "x": _w((lambda *s: torch.randn(*s, dtype=torch.bfloat16) * 0.8)(B, Sq, D)),
        "k_cache": _w((lambda *s: torch.randn(*s, dtype=torch.bfloat16) * 0.8)(B, H, Sk, Dh)),
        "v_cache": _w((lambda *s: torch.randn(*s, dtype=torch.bfloat16) * 0.05)(B, H, Sk, Dh)),
        "wq": _w((lambda *s: torch.randn(*s, dtype=torch.bfloat16) * 0.8)(D, H * Dh) * (D ** -0.5)),
        "wo": _w((lambda *s: torch.randn(*s, dtype=torch.bfloat16) * 0.05)(H * Dh, D) * ((H * Dh) ** -0.5)),
    }

def reference(x, k_cache, v_cache, wq, wo):
    B, Sq, D = x.shape
    H, Dh = 32, 128
    q = (lambda x, *d: x.permute(*d))((x @ wq).reshape(B, Sq, H, Dh), 0, 2, 1, 3)
    scores = torch.einsum("bhqd,bhkd->bhqk", q, k_cache) * (Dh ** -0.5)
    p = _softmax(scores, axis=-1)
    o = torch.einsum("bhqk,bhkd->bhqd", p, v_cache)
    return (lambda x, *d: x.permute(*d))(o, 0, 2, 1, 3).reshape(B, Sq, H * Dh) @ wo
```

```asm
; @launch grid=(256,1,1) block=(256,1,1) lds=163840
.amdgcn_target "amdgcn-amd-amdhsa--gfx950"
.text
.globl standalone__mha_block_cached__near_ridge_kernel
.p2align 8
.type standalone__mha_block_cached__near_ridge_kernel,@function
standalone__mha_block_cached__near_ridge_kernel:
  s_cmp_ge_u32 s2, 256
  s_cbranch_scc1 L_end
  v_lshrrev_b32 v2, 6, v0
  s_mov_b32 s69, 0
  s_mov_b32 s3, 0
  v_readfirstlane_b32 s24, v2
L_restart:
  s_load_dwordx16 s[32:47], s[0:1], 0
  v_mbcnt_lo_u32_b32 v32, -1, 0
  v_mbcnt_hi_u32_b32 v32, -1, v32
  v_and_b32 v33, 15, v32
  v_lshrrev_b32 v34, 4, v32
  v_lshrrev_b32 v35, 2, v33
  v_and_b32 v36, 3, v32
  v_lshlrev_b32 v1, 4, v32
  s_and_b32 s48, s2, 7
  s_lshr_b32 s49, s2, 3
  s_lshl_b32 s48, s48, 1
  s_lshr_b32 s50, s49, 4
  s_add_u32 s66, s48, s50
  s_and_b32 s67, s49, 15
  s_lshl_b32 s25, s24, 12
  v_lshrrev_b32 v38, 5, v32
  v_and_b32 v39, 31, v32
  v_add_u32 v37, 0, v38
  v_lshlrev_b32 v37, 2, v37
  v_xor_b32 v37, v37, v39
  v_lshlrev_b32 v37, 4, v37
  v_lshl_add_u32 v37, v38, 13, v37
  v_add_u32 v14, 0, v37
  v_add_u32 v37, 2, v38
  v_lshlrev_b32 v37, 2, v37
  v_xor_b32 v37, v37, v39
  v_lshlrev_b32 v37, 4, v37
  v_lshl_add_u32 v37, v38, 13, v37
  v_add_u32 v15, 15360, v37
  v_add_u32 v37, 0, v38
  v_lshlrev_b32 v37, 2, v37
  v_xor_b32 v37, v37, v39
  v_lshlrev_b32 v37, 4, v37
  v_lshl_add_u32 v37, v38, 13, v37
  v_add_u32 v16, 30720, v37
  v_add_u32 v37, 2, v38
  v_lshlrev_b32 v37, 2, v37
  v_xor_b32 v37, v37, v39
  v_lshlrev_b32 v37, 4, v37
  v_lshl_add_u32 v37, v38, 13, v37
  v_add_u32 v17, 46080, v37
  v_lshrrev_b32 v37, 3, v32
  v_and_b32 v37, 2, v37
  v_xor_b32 v37, v37, v36
  v_lshlrev_b32 v37, 4, v37
  v_lshrrev_b32 v38, 2, v32
  v_lshl_add_u32 v18, v38, 10, v37
  v_add_u32 v19, 15360, v18
  s_lshl_b32 s59, s24, 16
  s_mov_b32 s63, s59
  s_add_u32 s48, s67, s66
  s_and_b32 s48, s48, 15
  s_lshl_b32 s56, s48, 18
  s_lshl_b32 s60, s48, 6
  s_mov_b32 s57, 0x40000
  s_mov_b32 s58, 0x3fffff
  s_mov_b32 s61, 64
  s_mov_b32 s62, 0x3ff
  s_mov_b32 s64, 30720
  s_add_u32 s26, s56, s59
  s_add_u32 s27, s60, s63
  s_add_u32 s28, s27, s64
  s_mov_b32 s29, s25
  s_mov_b32 s65, s25
  s_waitcnt lgkmcnt(0)
  s_lshl_b32 s51, s66, 18
  s_add_u32 s32, s32, s51
  s_addc_u32 s33, s33, 0
  s_mov_b32 s8, s32
  s_and_b32 s9, s33, 0xffff
  s_mov_b32 s10, 0x40000
  s_mov_b32 s11, 0x20000
  s_lshl_b32 s51, s67, 9
  s_add_u32 s38, s38, s51
  s_addc_u32 s39, s39, 0
  s_mov_b32 s4, s38
  s_and_b32 s5, s39, 0xffff
  s_mov_b32 s6, 0x400000
  s_mov_b32 s7, 0x20000
  s_sub_u32 s6, s6, s51
  s_mov_b32 m0, s29
  s_nop 0
  buffer_load_dwordx4 v14, s[4:7], s26 offen offset:0 lds
  buffer_load_dwordx4 v15, s[4:7], s26 offen offset:1024 lds
  buffer_load_dwordx4 v16, s[4:7], s26 offen offset:2048 lds
  buffer_load_dwordx4 v17, s[4:7], s26 offen offset:3072 lds
  s_add_u32 s29, s29, 0x4000
  s_and_b32 s29, s29, 0xffff
  s_add_u32 s56, s56, s57
  s_and_b32 s56, s56, s58
  s_add_u32 s26, s56, s59
  s_add_u32 m0, s65, 0x10000
  s_nop 0
  buffer_load_dwordx4 v18, s[8:11], s27 offen offset:0 lds
  buffer_load_dwordx4 v19, s[8:11], s27 offen offset:1024 lds
  buffer_load_dwordx4 v18, s[8:11], s28 offen offset:2048 lds
  buffer_load_dwordx4 v19, s[8:11], s28 offen offset:3072 lds
  s_add_u32 s65, s65, 0x4000
  s_and_b32 s65, s65, 0xffff
  s_add_u32 s60, s60, s61
  s_and_b32 s60, s60, s62
  s_add_u32 s27, s60, s63
  s_add_u32 s28, s27, s64
  s_mov_b32 m0, s29
  s_nop 0
  buffer_load_dwordx4 v14, s[4:7], s26 offen offset:0 lds
  buffer_load_dwordx4 v15, s[4:7], s26 offen offset:1024 lds
  buffer_load_dwordx4 v16, s[4:7], s26 offen offset:2048 lds
  buffer_load_dwordx4 v17, s[4:7], s26 offen offset:3072 lds
  s_add_u32 s29, s29, 0x4000
  s_and_b32 s29, s29, 0xffff
  s_add_u32 s56, s56, s57
  s_and_b32 s56, s56, s58
  s_add_u32 s26, s56, s59
  s_add_u32 m0, s65, 0x10000
  s_nop 0
  buffer_load_dwordx4 v18, s[8:11], s27 offen offset:0 lds
  buffer_load_dwordx4 v19, s[8:11], s27 offen offset:1024 lds
  buffer_load_dwordx4 v18, s[8:11], s28 offen offset:2048 lds
  buffer_load_dwordx4 v19, s[8:11], s28 offen offset:3072 lds
  s_add_u32 s65, s65, 0x4000
  s_and_b32 s65, s65, 0xffff
  s_add_u32 s60, s60, s61
  s_and_b32 s60, s60, s62
  s_add_u32 s27, s60, s63
  s_add_u32 s28, s27, s64
  s_mov_b32 m0, s29
  s_nop 0
  buffer_load_dwordx4 v14, s[4:7], s26 offen offset:0 lds
  buffer_load_dwordx4 v15, s[4:7], s26 offen offset:1024 lds
  buffer_load_dwordx4 v16, s[4:7], s26 offen offset:2048 lds
  buffer_load_dwordx4 v17, s[4:7], s26 offen offset:3072 lds
  s_add_u32 s29, s29, 0x4000
  s_and_b32 s29, s29, 0xffff
  s_add_u32 s56, s56, s57
  s_and_b32 s56, s56, s58
  s_add_u32 s26, s56, s59
  s_add_u32 m0, s65, 0x10000
  s_nop 0
  buffer_load_dwordx4 v18, s[8:11], s27 offen offset:0 lds
  buffer_load_dwordx4 v19, s[8:11], s27 offen offset:1024 lds
  buffer_load_dwordx4 v18, s[8:11], s28 offen offset:2048 lds
  buffer_load_dwordx4 v19, s[8:11], s28 offen offset:3072 lds
  s_add_u32 s65, s65, 0x4000
  s_and_b32 s65, s65, 0xffff
  s_add_u32 s60, s60, s61
  s_and_b32 s60, s60, s62
  s_add_u32 s27, s60, s63
  s_add_u32 s28, s27, s64
  s_getpc_b64 s[52:53]
L_pc:
  s_and_b32 s52, s52, 0xffffff00
  s_mov_b32 s72, s52
  s_and_b32 s73, s53, 0xffff
  s_mov_b32 s74, L_code_hot_end-L_pc
  s_mov_b32 s75, 0x20000
  s_lshr_b32 s48, s2, 3
  s_lshl_b32 s48, s48, 2
  s_add_u32 s48, s48, s24
  s_and_b32 s48, s48, 63
  s_lshl_b32 s48, s48, 10
  s_lshl_b32 s49, s24, 10
  s_add_u32 m0, s49, 0x21000
  s_and_b32 s51, s67, 7
  buffer_load_dwordx4 v1, s[72:75], s48 offen lds
  s_lshl_b32 s51, s51, 7
  s_add_u32 s40, s40, s51
  s_addc_u32 s41, s41, 0
  s_mov_b32 s80, s40
  s_and_b32 s81, s41, 0xffff
  s_mov_b32 s82, 0x400000
  s_mov_b32 s83, 0x20000
  s_sub_u32 s82, s82, s51
  s_lshl_b32 s48, s2, 2
  s_add_u32 s48, s48, s24
  s_lshl_b32 s48, s48, 12
  buffer_load_dwordx4 v1, s[80:83], s48 offen lds
  s_add_u32 s48, s48, 0x400
  buffer_load_dwordx4 v1, s[80:83], s48 offen lds
  s_add_u32 s48, s48, 0x400
  buffer_load_dwordx4 v1, s[80:83], s48 offen lds
  s_add_u32 s48, s48, 0x400
  buffer_load_dwordx4 v1, s[80:83], s48 offen lds
  s_add_u32 s48, s48, 0x400
  v_add_u32 v37, 0, v34
  v_xor_b32 v37, v37, v33
  v_lshlrev_b32 v37, 4, v37
  v_lshl_add_u32 v2, v33, 8, v37
  v_lshl_add_u32 v38, v34, 8, v37
  v_accvgpr_write_b32 a202, v38
  v_add_u32 v37, 4, v34
  v_xor_b32 v37, v37, v33
  v_lshlrev_b32 v37, 4, v37
  v_lshl_add_u32 v3, v33, 8, v37
  v_lshl_add_u32 v38, v34, 8, v37
  v_accvgpr_write_b32 a203, v38
  v_add_u32 v37, 8, v34
  v_xor_b32 v37, v37, v33
  v_lshlrev_b32 v37, 4, v37
  v_lshl_add_u32 v4, v33, 8, v37
  v_lshl_add_u32 v38, v34, 8, v37
  v_accvgpr_write_b32 a204, v38
  v_add_u32 v37, 12, v34
  v_xor_b32 v37, v37, v33
  v_lshlrev_b32 v37, 4, v37
  v_lshl_add_u32 v5, v33, 8, v37
  v_lshl_add_u32 v38, v34, 8, v37
  v_accvgpr_write_b32 a205, v38
  v_and_b32 v38, 1, v34
  v_lshl_add_u32 v38, v38, 2, v35
  v_lshl_add_u32 v39, v34, 2, v35
  v_lshlrev_b32 v39, 8, v39
  v_lshl_add_u32 v39, v36, 3, v39
  v_add_u32 v39, 0x10000, v39
  v_xor_b32 v37, 0, v38
  v_lshl_add_u32 v6, v37, 5, v39
  v_xor_b32 v37, 1, v38
  v_lshl_add_u32 v7, v37, 5, v39
  v_xor_b32 v37, 2, v38
  v_lshl_add_u32 v8, v37, 5, v39
  v_xor_b32 v37, 3, v38
  v_lshl_add_u32 v9, v37, 5, v39
  v_xor_b32 v37, 4, v38
  v_lshl_add_u32 v10, v37, 5, v39
  v_xor_b32 v37, 5, v38
  v_lshl_add_u32 v11, v37, 5, v39
  v_xor_b32 v37, 6, v38
  v_lshl_add_u32 v12, v37, 5, v39
  v_xor_b32 v37, 7, v38
  v_lshl_add_u32 v13, v37, 5, v39
  v_add_u32 v37, 0, v34
  v_lshlrev_b32 v37, 1, v37
  v_xor_b32 v37, v37, v33
  v_lshlrev_b32 v37, 4, v37
  v_lshl_add_u32 v37, v34, 8, v37
  v_accvgpr_write_b32 a200, v37
  v_add_u32 v37, 4, v34
  v_lshlrev_b32 v37, 1, v37
  v_xor_b32 v37, v37, v33
  v_lshlrev_b32 v37, 4, v37
  v_lshl_add_u32 v37, v34, 8, v37
  v_accvgpr_write_b32 a201, v37
  v_lshl_add_u32 v39, v34, 3, v35
  v_lshlrev_b32 v39, 9, v39
  v_lshl_add_u32 v39, v36, 4, v39
  v_xor_b32 v37, 0, v35
  v_lshl_add_u32 v20, v37, 6, v39
  v_xor_b32 v37, 1, v35
  v_lshl_add_u32 v21, v37, 6, v39
  v_xor_b32 v37, 2, v35
  v_lshl_add_u32 v22, v37, 6, v39
  v_xor_b32 v37, 3, v35
  v_lshl_add_u32 v23, v37, 6, v39
  v_lshrrev_b32 v37, 1, v33
  v_and_b32 v37, 2, v37
  v_xor_b32 v37, v37, v34
  v_lshlrev_b32 v37, 4, v37
  v_lshl_add_u32 v37, v33, 6, v37
  v_add_u32 v37, 0x10000, v37
  v_add_u32 v24, s25, v37
  v_lshlrev_b32 v30, 2, v32
  v_add_u32 v30, 0x27f00, v30
  v_mov_b32 v37, 0
  v_add_u32 v38, -256, v30
  v_mov_b32 v39, 1
  v_accvgpr_write_b32 a255, v39
  s_cmp_lg_u32 s24, 0
  s_cbranch_scc1 L_nozero
  ds_write_b32 v30, v37
  ds_write_b32 v38, v37
L_nozero:
  v_mov_b32 v64, 0
  v_mov_b32 v65, 0
  v_mov_b32 v66, 0
  v_mov_b32 v67, 0
  s_mov_b32 s68, 4
  s_lshl_b32 s50, s66, 4
  v_mfma_f32_32x32x16_bf16 a[0:15], v[64:67], v[64:67], 0
  v_mfma_f32_32x32x16_bf16 a[16:31], v[64:67], v[64:67], 0
  v_mfma_f32_32x32x16_bf16 a[32:47], v[64:67], v[64:67], 0
  v_mfma_f32_32x32x16_bf16 a[48:63], v[64:67], v[64:67], 0
  v_mfma_f32_32x32x16_bf16 a[64:79], v[64:67], v[64:67], 0
  v_mfma_f32_32x32x16_bf16 a[80:95], v[64:67], v[64:67], 0
  v_mfma_f32_32x32x16_bf16 a[96:111], v[64:67], v[64:67], 0
  v_mfma_f32_32x32x16_bf16 a[112:127], v[64:67], v[64:67], 0
  v_mfma_f32_32x32x16_bf16 v[128:143], v[64:67], v[64:67], 0
  v_mfma_f32_32x32x16_bf16 v[144:159], v[64:67], v[64:67], 0
  v_mfma_f32_32x32x16_bf16 v[160:175], v[64:67], v[64:67], 0
  v_mfma_f32_32x32x16_bf16 v[176:191], v[64:67], v[64:67], 0
  v_mfma_f32_32x32x16_bf16 v[192:207], v[64:67], v[64:67], 0
  v_mfma_f32_32x32x16_bf16 v[208:223], v[64:67], v[64:67], 0
  v_mfma_f32_32x32x16_bf16 v[224:239], v[64:67], v[64:67], 0
  v_mfma_f32_32x32x16_bf16 v[240:255], v[64:67], v[64:67], 0
  v_mfma_f32_32x32x16_bf16 v[112:127], v[64:67], v[64:67], 0
  s_add_u32 s50, s50, s67
  s_lshl_b32 s51, s50, 19
  s_add_u32 s34, s34, s51
  s_addc_u32 s35, s35, 0
  s_add_u32 s36, s36, s51
  s_addc_u32 s37, s37, 0
  s_mov_b32 s12, s34
  s_and_b32 s13, s35, 0xffff
  s_mov_b32 s14, 0x80000
  s_mov_b32 s15, 0x20000
  s_mov_b32 s16, s36
  s_and_b32 s17, s37, 0xffff
  s_mov_b32 s18, 0x80000
  s_mov_b32 s19, 0x20000
  s_lshl_b32 s51, s66, 21
  s_add_u32 s52, s46, s51
  s_addc_u32 s53, s47, 0
  s_mov_b32 s20, s52
  s_and_b32 s21, s53, 0xffff
  s_mov_b32 s22, 0x200000
  s_mov_b32 s23, 0x20000
  s_mov_b32 s76, s44
  s_and_b32 s77, s45, 0xffff
  s_mov_b32 s78, 0x100
  s_mov_b32 s79, 0x20000
  s_mov_b32 s84, s42
  s_and_b32 s85, s43, 0xffff
  s_mov_b32 s86, 0x400000
  s_mov_b32 s87, 0x20000
  v_mfma_f32_32x32x16_bf16 v[48:63], v[64:67], v[64:67], 0
  s_and_b32 s51, s67, 7
  s_lshl_b32 s51, s51, 7
  s_lshr_b32 s52, s67, 3
  s_lshl_b32 s93, s52, 13
  s_lshl_b32 s94, s66, 18
  s_lshl_b32 s53, s52, 17
  s_add_u32 s94, s94, s53
  s_lshl_b32 s53, s24, 15
  s_add_u32 s94, s94, s53
  s_add_u32 s94, s94, s51
  s_lshl_b32 s92, s66, 4
  s_lshl_b32 s101, s24, 2
  s_add_u32 s101, s101, s92
  s_lshr_b32 s48, s67, 2
  s_lshl_b32 s49, s66, 2
  s_add_u32 s95, s48, s49
  s_lshl_b32 s95, s95, 2
  s_lshl_b32 s91, s24, 15
  s_cmp_eq_u32 s24, 3
  s_cselect_b32 s91, 0x20000, s91
  s_lshl_b32 s31, s67, 17
  s_add_u32 s31, s31, s25
  s_mov_b32 s30, 0
  s_waitcnt vmcnt(21) lgkmcnt(0)
  s_barrier
L_qloop:
  v_mfma_f32_16x16x32_bf16 v[192:195], v[112:115], v[48:51], v[192:195]
  ds_read_b128 v[32:35], v24 offset:0
  v_mfma_f32_16x16x32_bf16 v[196:199], v[112:115], v[52:55], v[196:199]
  ds_read_b128 v[36:39], v24 offset:1024
  ds_read_b64_tr_b16 v[64:65], v20 offset:0
  v_mfma_f32_16x16x32_bf16 v[200:203], v[112:115], v[56:59], v[200:203]
  ds_read_b128 v[40:43], v24 offset:2048
  ds_read_b64_tr_b16 v[66:67], v20 offset:2048
  v_mfma_f32_16x16x32_bf16 v[204:207], v[112:115], v[60:63], v[204:207]
  ds_read_b128 v[44:47], v24 offset:3072
  ds_read_b64_tr_b16 v[68:69], v20 offset:8
  v_mfma_f32_16x16x32_bf16 v[208:211], v[116:119], v[48:51], v[208:211]
  ds_read_b64_tr_b16 v[70:71], v20 offset:2056
  v_mfma_f32_16x16x32_bf16 v[212:215], v[116:119], v[52:55], v[212:215]
  s_mov_b32 m0, s29
  v_mfma_f32_16x16x32_bf16 v[216:219], v[116:119], v[56:59], v[216:219]
  ds_read_b64_tr_b16 v[72:73], v21 offset:0
  buffer_load_dwordx4 v14, s[4:7], s26 offen offset:0 lds
  v_mfma_f32_16x16x32_bf16 v[220:223], v[116:119], v[60:63], v[220:223]
  ds_read_b64_tr_b16 v[74:75], v21 offset:2048
  v_mfma_f32_16x16x32_bf16 v[224:227], v[120:123], v[48:51], v[224:227]
  ds_read_b64_tr_b16 v[76:77], v21 offset:8
  v_mfma_f32_16x16x32_bf16 v[228:231], v[120:123], v[52:55], v[228:231]
  v_mfma_f32_16x16x32_bf16 v[232:235], v[120:123], v[56:59], v[232:235]
  ds_read_b64_tr_b16 v[78:79], v21 offset:2056
  v_mfma_f32_16x16x32_bf16 v[236:239], v[120:123], v[60:63], v[236:239]
  ds_read_b64_tr_b16 v[80:81], v22 offset:0
  buffer_load_dwordx4 v15, s[4:7], s26 offen offset:1024 lds
  v_mfma_f32_16x16x32_bf16 v[240:243], v[124:127], v[48:51], v[240:243]
  ds_read_b64_tr_b16 v[82:83], v22 offset:2048
  v_mfma_f32_16x16x32_bf16 v[244:247], v[124:127], v[52:55], v[244:247]
  v_mfma_f32_16x16x32_bf16 v[248:251], v[124:127], v[56:59], v[248:251]
  ds_read_b64_tr_b16 v[84:85], v22 offset:8
  v_mfma_f32_16x16x32_bf16 v[252:255], v[124:127], v[60:63], v[252:255]
  s_waitcnt lgkmcnt(10)
  ds_read_b64_tr_b16 v[86:87], v22 offset:2056
  buffer_load_dwordx4 v16, s[4:7], s26 offen offset:2048 lds
  v_mfma_f32_16x16x32_bf16 a[0:3], v[64:67], v[32:35], a[0:3]
  ds_read_b64_tr_b16 v[88:89], v23 offset:0
  v_mfma_f32_16x16x32_bf16 a[4:7], v[64:67], v[36:39], a[4:7]
  ds_read_b64_tr_b16 v[90:91], v23 offset:2048
  v_mfma_f32_16x16x32_bf16 a[8:11], v[64:67], v[40:43], a[8:11]
  s_waitcnt lgkmcnt(12)
  v_mfma_f32_16x16x32_bf16 a[12:15], v[64:67], v[44:47], a[12:15]
  s_waitcnt lgkmcnt(10)
  ds_read_b64_tr_b16 v[92:93], v23 offset:8
  v_mfma_f32_16x16x32_bf16 a[16:19], v[68:71], v[32:35], a[16:19]
  ds_read_b64_tr_b16 v[94:95], v23 offset:2056
  buffer_load_dwordx4 v17, s[4:7], s26 offen offset:3072 lds
  v_mfma_f32_16x16x32_bf16 a[20:23], v[68:71], v[36:39], a[20:23]
  s_add_u32 s29, s29, 0x4000
  s_and_b32 s29, s29, 0xffff
  ds_read_b64_tr_b16 v[96:97], v20 offset:256
  v_mfma_f32_16x16x32_bf16 a[24:27], v[68:71], v[40:43], a[24:27]
  s_add_u32 s56, s56, s57
  s_and_b32 s56, s56, s58
  v_mfma_f32_16x16x32_bf16 a[28:31], v[68:71], v[44:47], a[28:31]
  s_waitcnt lgkmcnt(11)
  s_add_u32 s26, s56, s59
  ds_read_b64_tr_b16 v[98:99], v20 offset:2304
  v_mfma_f32_16x16x32_bf16 a[32:35], v[72:75], v[32:35], a[32:35]
  s_add_u32 m0, s65, 0x10000
  ds_read_b64_tr_b16 v[100:101], v20 offset:264
  v_mfma_f32_16x16x32_bf16 a[36:39], v[72:75], v[36:39], a[36:39]
  ds_read_b64_tr_b16 v[102:103], v20 offset:2312
  buffer_load_dwordx4 v18, s[8:11], s27 offen offset:0 lds
  v_mfma_f32_16x16x32_bf16 a[40:43], v[72:75], v[40:43], a[40:43]
  v_mfma_f32_16x16x32_bf16 a[44:47], v[72:75], v[44:47], a[44:47]
  s_waitcnt lgkmcnt(12)
  ds_read_b64_tr_b16 v[104:105], v21 offset:256
  v_mfma_f32_16x16x32_bf16 a[48:51], v[76:79], v[32:35], a[48:51]
  ds_read_b64_tr_b16 v[106:107], v21 offset:2304
  v_mfma_f32_16x16x32_bf16 a[52:55], v[76:79], v[36:39], a[52:55]
  ds_read_b64_tr_b16 v[108:109], v21 offset:264
  v_mfma_f32_16x16x32_bf16 a[56:59], v[76:79], v[40:43], a[56:59]
  ds_read_b64_tr_b16 v[110:111], v21 offset:2312
  buffer_load_dwordx4 v19, s[8:11], s27 offen offset:1024 lds
  v_mfma_f32_16x16x32_bf16 a[60:63], v[76:79], v[44:47], a[60:63]
  s_waitcnt lgkmcnt(14)
  v_mfma_f32_16x16x32_bf16 a[64:67], v[80:83], v[32:35], a[64:67]
  ds_read_b64_tr_b16 v[112:113], v22 offset:256
  v_mfma_f32_16x16x32_bf16 a[68:71], v[80:83], v[36:39], a[68:71]
  ds_read_b64_tr_b16 v[114:115], v22 offset:2304
  v_mfma_f32_16x16x32_bf16 a[72:75], v[80:83], v[40:43], a[72:75]
  ds_read_b64_tr_b16 v[116:117], v22 offset:264
  buffer_load_dwordx4 v18, s[8:11], s28 offen offset:2048 lds
  v_mfma_f32_16x16x32_bf16 a[76:79], v[80:83], v[44:47], a[76:79]
  s_waitcnt lgkmcnt(15)
  v_mfma_f32_16x16x32_bf16 a[80:83], v[84:87], v[32:35], a[80:83]
  ds_read_b64_tr_b16 v[118:119], v22 offset:2312
  v_mfma_f32_16x16x32_bf16 a[84:87], v[84:87], v[36:39], a[84:87]
  ds_read_b64_tr_b16 v[120:121], v23 offset:256
  v_mfma_f32_16x16x32_bf16 a[88:91], v[84:87], v[40:43], a[88:91]
  ds_read_b64_tr_b16 v[122:123], v23 offset:2304
  v_mfma_f32_16x16x32_bf16 a[92:95], v[84:87], v[44:47], a[92:95]
  s_waitcnt lgkmcnt(15)
  buffer_load_dwordx4 v19, s[8:11], s28 offen offset:3072 lds
  v_mfma_f32_16x16x32_bf16 a[96:99], v[88:91], v[32:35], a[96:99]
  s_add_u32 s65, s65, 0x4000
  s_and_b32 s65, s65, 0xffff
  ds_read_b64_tr_b16 v[124:125], v23 offset:264
  v_mfma_f32_16x16x32_bf16 a[100:103], v[88:91], v[36:39], a[100:103]
  s_add_u32 s60, s60, s61
  s_and_b32 s60, s60, s62
  ds_read_b64_tr_b16 v[126:127], v23 offset:2312
  v_mfma_f32_16x16x32_bf16 a[104:107], v[88:91], v[40:43], a[104:107]
  s_add_u32 s27, s60, s63
  s_add_u32 s28, s27, s64
  v_mfma_f32_16x16x32_bf16 a[108:111], v[88:91], v[44:47], a[108:111]
  s_waitcnt lgkmcnt(15)
  v_mfma_f32_16x16x32_bf16 a[112:115], v[92:95], v[32:35], a[112:115]
  v_mfma_f32_16x16x32_bf16 a[116:119], v[92:95], v[36:39], a[116:119]
  v_mfma_f32_16x16x32_bf16 a[120:123], v[92:95], v[40:43], a[120:123]
  v_mfma_f32_16x16x32_bf16 a[124:127], v[92:95], v[44:47], a[124:127]
  s_waitcnt vmcnt(16) lgkmcnt(0)
  ds_add_u32 v30, a255
  v_mfma_f32_16x16x32_bf16 v[128:131], v[96:99], v[32:35], v[128:131]
  v_mfma_f32_16x16x32_bf16 v[132:135], v[96:99], v[36:39], v[132:135]
  v_mfma_f32_16x16x32_bf16 v[136:139], v[96:99], v[40:43], v[136:139]
  v_mfma_f32_16x16x32_bf16 v[140:143], v[96:99], v[44:47], v[140:143]
  v_mfma_f32_16x16x32_bf16 v[144:147], v[100:103], v[32:35], v[144:147]
  v_mfma_f32_16x16x32_bf16 v[148:151], v[100:103], v[36:39], v[148:151]
  v_mfma_f32_16x16x32_bf16 v[152:155], v[100:103], v[40:43], v[152:155]
  v_mfma_f32_16x16x32_bf16 v[156:159], v[100:103], v[44:47], v[156:159]
  ds_read_b32 v0, v30
  v_mfma_f32_16x16x32_bf16 v[160:163], v[104:107], v[32:35], v[160:163]
  v_mfma_f32_16x16x32_bf16 v[164:167], v[104:107], v[36:39], v[164:167]
  v_mfma_f32_16x16x32_bf16 v[168:171], v[104:107], v[40:43], v[168:171]
  v_mfma_f32_16x16x32_bf16 v[172:175], v[104:107], v[44:47], v[172:175]
  v_mfma_f32_16x16x32_bf16 v[176:179], v[108:111], v[32:35], v[176:179]
  v_mfma_f32_16x16x32_bf16 v[180:183], v[108:111], v[36:39], v[180:183]
  s_waitcnt lgkmcnt(0)
  v_cmp_gt_u32 vcc, s68, v0
  v_mfma_f32_16x16x32_bf16 v[184:187], v[108:111], v[40:43], v[184:187]
  s_cbranch_vccnz L_spin1
L_spin1_ret:
  s_add_u32 s68, s68, 4
  v_mfma_f32_16x16x32_bf16 v[188:191], v[108:111], v[44:47], v[188:191]
  s_cmp_eq_u32 s30, 6
  s_cbranch_scc1 L_qtail
  v_mfma_f32_16x16x32_bf16 v[192:195], v[112:115], v[32:35], v[192:195]
  ds_read_b128 v[48:51], v24 offset:16384
  v_mfma_f32_16x16x32_bf16 v[196:199], v[112:115], v[36:39], v[196:199]
  ds_read_b128 v[52:55], v24 offset:17408
  ds_read_b64_tr_b16 v[64:65], v20 offset:16384
  v_mfma_f32_16x16x32_bf16 v[200:203], v[112:115], v[40:43], v[200:203]
  ds_read_b128 v[56:59], v24 offset:18432
  ds_read_b64_tr_b16 v[66:67], v20 offset:18432
  v_mfma_f32_16x16x32_bf16 v[204:207], v[112:115], v[44:47], v[204:207]
  ds_read_b128 v[60:63], v24 offset:19456
  ds_read_b64_tr_b16 v[68:69], v20 offset:16392
  v_mfma_f32_16x16x32_bf16 v[208:211], v[116:119], v[32:35], v[208:211]
  ds_read_b64_tr_b16 v[70:71], v20 offset:18440
  v_mfma_f32_16x16x32_bf16 v[212:215], v[116:119], v[36:39], v[212:215]
  s_mov_b32 m0, s29
  v_mfma_f32_16x16x32_bf16 v[216:219], v[116:119], v[40:43], v[216:219]
  ds_read_b64_tr_b16 v[72:73], v21 offset:16384
  buffer_load_dwordx4 v14, s[4:7], s26 offen offset:0 lds
  v_mfma_f32_16x16x32_bf16 v[220:223], v[116:119], v[44:47], v[220:223]
  ds_read_b64_tr_b16 v[74:75], v21 offset:18432
  v_mfma_f32_16x16x32_bf16 v[224:227], v[120:123], v[32:35], v[224:227]
  ds_read_b64_tr_b16 v[76:77], v21 offset:16392
  v_mfma_f32_16x16x32_bf16 v[228:231], v[120:123], v[36:39], v[228:231]
  v_mfma_f32_16x16x32_bf16 v[232:235], v[120:123], v[40:43], v[232:235]
  ds_read_b64_tr_b16 v[78:79], v21 offset:18440
  v_mfma_f32_16x16x32_bf16 v[236:239], v[120:123], v[44:47], v[236:239]
  ds_read_b64_tr_b16 v[80:81], v22 offset:16384
  buffer_load_dwordx4 v15, s[4:7], s26 offen offset:1024 lds
  v_mfma_f32_16x16x32_bf16 v[240:243], v[124:127], v[32:35], v[240:243]
  ds_read_b64_tr_b16 v[82:83], v22 offset:18432
  v_mfma_f32_16x16x32_bf16 v[244:247], v[124:127], v[36:39], v[244:247]
  v_mfma_f32_16x16x32_bf16 v[248:251], v[124:127], v[40:43], v[248:251]
  ds_read_b64_tr_b16 v[84:85], v22 offset:16392
  v_mfma_f32_16x16x32_bf16 v[252:255], v[124:127], v[44:47], v[252:255]
  s_waitcnt lgkmcnt(10)
  ds_read_b64_tr_b16 v[86:87], v22 offset:18440
  buffer_load_dwordx4 v16, s[4:7], s26 offen offset:2048 lds
  v_mfma_f32_16x16x32_bf16 a[0:3], v[64:67], v[48:51], a[0:3]
  ds_read_b64_tr_b16 v[88:89], v23 offset:16384
  v_mfma_f32_16x16x32_bf16 a[4:7], v[64:67], v[52:55], a[4:7]
  ds_read_b64_tr_b16 v[90:91], v23 offset:18432
  v_mfma_f32_16x16x32_bf16 a[8:11], v[64:67], v[56:59], a[8:11]
  s_waitcnt lgkmcnt(12)
  v_mfma_f32_16x16x32_bf16 a[12:15], v[64:67], v[60:63], a[12:15]
  s_waitcnt lgkmcnt(10)
  ds_read_b64_tr_b16 v[92:93], v23 offset:16392
  v_mfma_f32_16x16x32_bf16 a[16:19], v[68:71], v[48:51], a[16:19]
  ds_read_b64_tr_b16 v[94:95], v23 offset:18440
  buffer_load_dwordx4 v17, s[4:7], s26 offen offset:3072 lds
  v_mfma_f32_16x16x32_bf16 a[20:23], v[68:71], v[52:55], a[20:23]
  s_add_u32 s29, s29, 0x4000
  s_and_b32 s29, s29, 0xffff
  ds_read_b64_tr_b16 v[96:97], v20 offset:16640
  v_mfma_f32_16x16x32_bf16 a[24:27], v[68:71], v[56:59], a[24:27]
  s_add_u32 s56, s56, s57
  s_and_b32 s56, s56, s58
  v_mfma_f32_16x16x32_bf16 a[28:31], v[68:71], v[60:63], a[28:31]
  s_waitcnt lgkmcnt(11)
  s_add_u32 s26, s56, s59
  ds_read_b64_tr_b16 v[98:99], v20 offset:18688
  v_mfma_f32_16x16x32_bf16 a[32:35], v[72:75], v[48:51], a[32:35]
  s_add_u32 m0, s65, 0x10000
  ds_read_b64_tr_b16 v[100:101], v20 offset:16648
  v_mfma_f32_16x16x32_bf16 a[36:39], v[72:75], v[52:55], a[36:39]
  ds_read_b64_tr_b16 v[102:103], v20 offset:18696
  buffer_load_dwordx4 v18, s[8:11], s27 offen offset:0 lds
  v_mfma_f32_16x16x32_bf16 a[40:43], v[72:75], v[56:59], a[40:43]
  v_mfma_f32_16x16x32_bf16 a[44:47], v[72:75], v[60:63], a[44:47]
  s_waitcnt lgkmcnt(12)
  ds_read_b64_tr_b16 v[104:105], v21 offset:16640
  v_mfma_f32_16x16x32_bf16 a[48:51], v[76:79], v[48:51], a[48:51]
  ds_read_b64_tr_b16 v[106:107], v21 offset:18688
  v_mfma_f32_16x16x32_bf16 a[52:55], v[76:79], v[52:55], a[52:55]
  ds_read_b64_tr_b16 v[108:109], v21 offset:16648
  v_mfma_f32_16x16x32_bf16 a[56:59], v[76:79], v[56:59], a[56:59]
  ds_read_b64_tr_b16 v[110:111], v21 offset:18696
  buffer_load_dwordx4 v19, s[8:11], s27 offen offset:1024 lds
  v_mfma_f32_16x16x32_bf16 a[60:63], v[76:79], v[60:63], a[60:63]
  s_waitcnt lgkmcnt(14)
  v_mfma_f32_16x16x32_bf16 a[64:67], v[80:83], v[48:51], a[64:67]
  ds_read_b64_tr_b16 v[112:113], v22 offset:16640
  v_mfma_f32_16x16x32_bf16 a[68:71], v[80:83], v[52:55], a[68:71]
  ds_read_b64_tr_b16 v[114:115], v22 offset:18688
  v_mfma_f32_16x16x32_bf16 a[72:75], v[80:83], v[56:59], a[72:75]
  ds_read_b64_tr_b16 v[116:117], v22 offset:16648
  buffer_load_dwordx4 v18, s[8:11], s28 offen offset:2048 lds
  v_mfma_f32_16x16x32_bf16 a[76:79], v[80:83], v[60:63], a[76:79]
  s_waitcnt lgkmcnt(15)
  v_mfma_f32_16x16x32_bf16 a[80:83], v[84:87], v[48:51], a[80:83]
  ds_read_b64_tr_b16 v[118:119], v22 offset:18696
  v_mfma_f32_16x16x32_bf16 a[84:87], v[84:87], v[52:55], a[84:87]
  ds_read_b64_tr_b16 v[120:121], v23 offset:16640
  v_mfma_f32_16x16x32_bf16 a[88:91], v[84:87], v[56:59], a[88:91]
  ds_read_b64_tr_b16 v[122:123], v23 offset:18688
  v_mfma_f32_16x16x32_bf16 a[92:95], v[84:87], v[60:63], a[92:95]
  s_waitcnt lgkmcnt(15)
  buffer_load_dwordx4 v19, s[8:11], s28 offen offset:3072 lds
  v_mfma_f32_16x16x32_bf16 a[96:99], v[88:91], v[48:51], a[96:99]
  s_add_u32 s65, s65, 0x4000
  s_and_b32 s65, s65, 0xffff
  ds_read_b64_tr_b16 v[124:125], v23 offset:16648
  v_mfma_f32_16x16x32_bf16 a[100:103], v[88:91], v[52:55], a[100:103]
  s_add_u32 s60, s60, s61
  s_and_b32 s60, s60, s62
  ds_read_b64_tr_b16 v[126:127], v23 offset:18696
  v_mfma_f32_16x16x32_bf16 a[104:107], v[88:91], v[56:59], a[104:107]
  s_add_u32 s27, s60, s63
  s_add_u32 s28, s27, s64
  v_mfma_f32_16x16x32_bf16 a[108:111], v[88:91], v[60:63], a[108:111]
  s_waitcnt lgkmcnt(15)
  v_mfma_f32_16x16x32_bf16 a[112:115], v[92:95], v[48:51], a[112:115]
  v_mfma_f32_16x16x32_bf16 a[116:119], v[92:95], v[52:55], a[116:119]
  v_mfma_f32_16x16x32_bf16 a[120:123], v[92:95], v[56:59], a[120:123]
  v_mfma_f32_16x16x32_bf16 a[124:127], v[92:95], v[60:63], a[124:127]
  s_waitcnt vmcnt(16) lgkmcnt(0)
  ds_add_u32 v30, a255
  v_mfma_f32_16x16x32_bf16 v[128:131], v[96:99], v[48:51], v[128:131]
  v_mfma_f32_16x16x32_bf16 v[132:135], v[96:99], v[52:55], v[132:135]
  v_xor_b32 v20, 0x8000, v20
  v_mfma_f32_16x16x32_bf16 v[136:139], v[96:99], v[56:59], v[136:139]
  v_xor_b32 v21, 0x8000, v21
  v_mfma_f32_16x16x32_bf16 v[140:143], v[96:99], v[60:63], v[140:143]
  v_xor_b32 v22, 0x8000, v22
  v_mfma_f32_16x16x32_bf16 v[144:147], v[100:103], v[48:51], v[144:147]
  v_xor_b32 v23, 0x8000, v23
  v_mfma_f32_16x16x32_bf16 v[148:151], v[100:103], v[52:55], v[148:151]
  v_xor_b32 v24, 0x8000, v24
  v_mfma_f32_16x16x32_bf16 v[152:155], v[100:103], v[56:59], v[152:155]
  v_mfma_f32_16x16x32_bf16 v[156:159], v[100:103], v[60:63], v[156:159]
  ds_read_b32 v0, v30
  v_mfma_f32_16x16x32_bf16 v[160:163], v[104:107], v[48:51], v[160:163]
  v_mfma_f32_16x16x32_bf16 v[164:167], v[104:107], v[52:55], v[164:167]
  v_mfma_f32_16x16x32_bf16 v[168:171], v[104:107], v[56:59], v[168:171]
  v_mfma_f32_16x16x32_bf16 v[172:175], v[104:107], v[60:63], v[172:175]
  v_mfma_f32_16x16x32_bf16 v[176:179], v[108:111], v[48:51], v[176:179]
  v_mfma_f32_16x16x32_bf16 v[180:183], v[108:111], v[52:55], v[180:183]
  s_waitcnt lgkmcnt(0)
  v_cmp_gt_u32 vcc, s68, v0
  v_mfma_f32_16x16x32_bf16 v[184:187], v[108:111], v[56:59], v[184:187]
  s_cbranch_vccnz L_spin2
L_spin2_ret:
  s_add_u32 s68, s68, 4
  v_mfma_f32_16x16x32_bf16 v[188:191], v[108:111], v[60:63], v[188:191]
  s_add_u32 s30, s30, 1
  s_branch L_qloop
L_qtail:
  s_mov_b32 s4, s12
  s_mov_b32 s8, s16
  s_mov_b32 s5, s13
  s_mov_b32 s9, s17
  s_mov_b32 s6, s14
  s_mov_b32 s10, s18
  s_mov_b32 s7, s15
  s_mov_b32 s11, s19
  v_accvgpr_read_b32 v14, a202
  v_accvgpr_read_b32 v15, a203
  v_accvgpr_read_b32 v16, a204
  v_accvgpr_read_b32 v17, a205
  v_accvgpr_read_b32 v18, a200
  v_accvgpr_read_b32 v19, a201
  s_add_u32 s26, s25, 0xc000
  s_mov_b32 s27, s25
  v_mfma_f32_16x16x32_bf16 v[192:195], v[112:115], v[32:35], v[192:195]
  ds_read_b128 v[48:51], v24 offset:16384
  v_mfma_f32_16x16x32_bf16 v[196:199], v[112:115], v[36:39], v[196:199]
  ds_read_b128 v[52:55], v24 offset:17408
  ds_read_b64_tr_b16 v[64:65], v20 offset:16384
  v_mfma_f32_16x16x32_bf16 v[200:203], v[112:115], v[40:43], v[200:203]
  ds_read_b128 v[56:59], v24 offset:18432
  ds_read_b64_tr_b16 v[66:67], v20 offset:18432
  v_mfma_f32_16x16x32_bf16 v[204:207], v[112:115], v[44:47], v[204:207]
  ds_read_b128 v[60:63], v24 offset:19456
  ds_read_b64_tr_b16 v[68:69], v20 offset:16392
  v_mfma_f32_16x16x32_bf16 v[208:211], v[116:119], v[32:35], v[208:211]
  ds_read_b64_tr_b16 v[70:71], v20 offset:18440
  v_mfma_f32_16x16x32_bf16 v[212:215], v[116:119], v[36:39], v[212:215]
  s_mov_b32 m0, s29
  v_mfma_f32_16x16x32_bf16 v[216:219], v[116:119], v[40:43], v[216:219]
  ds_read_b64_tr_b16 v[72:73], v21 offset:16384
  buffer_load_dwordx4 v14, s[4:7], s26 offen offset:0 nt lds
  v_mfma_f32_16x16x32_bf16 v[220:223], v[116:119], v[44:47], v[220:223]
  ds_read_b64_tr_b16 v[74:75], v21 offset:18432
  v_mfma_f32_16x16x32_bf16 v[224:227], v[120:123], v[32:35], v[224:227]
  ds_read_b64_tr_b16 v[76:77], v21 offset:16392
  v_mfma_f32_16x16x32_bf16 v[228:231], v[120:123], v[36:39], v[228:231]
  v_mfma_f32_16x16x32_bf16 v[232:235], v[120:123], v[40:43], v[232:235]
  ds_read_b64_tr_b16 v[78:79], v21 offset:18440
  v_mfma_f32_16x16x32_bf16 v[236:239], v[120:123], v[44:47], v[236:239]
  ds_read_b64_tr_b16 v[80:81], v22 offset:16384
  buffer_load_dwordx4 v15, s[4:7], s26 offen offset:1024 nt lds
  v_mfma_f32_16x16x32_bf16 v[240:243], v[124:127], v[32:35], v[240:243]
  ds_read_b64_tr_b16 v[82:83], v22 offset:18432
  v_mfma_f32_16x16x32_bf16 v[244:247], v[124:127], v[36:39], v[244:247]
  v_mfma_f32_16x16x32_bf16 v[248:251], v[124:127], v[40:43], v[248:251]
  ds_read_b64_tr_b16 v[84:85], v22 offset:16392
  v_mfma_f32_16x16x32_bf16 v[252:255], v[124:127], v[44:47], v[252:255]
  s_waitcnt lgkmcnt(10)
  ds_read_b64_tr_b16 v[86:87], v22 offset:18440
  buffer_load_dwordx4 v16, s[4:7], s26 offen offset:2048 nt lds
  v_mfma_f32_16x16x32_bf16 a[0:3], v[64:67], v[48:51], a[0:3]
  ds_read_b64_tr_b16 v[88:89], v23 offset:16384
  v_mfma_f32_16x16x32_bf16 a[4:7], v[64:67], v[52:55], a[4:7]
  ds_read_b64_tr_b16 v[90:91], v23 offset:18432
  v_mfma_f32_16x16x32_bf16 a[8:11], v[64:67], v[56:59], a[8:11]
  s_waitcnt lgkmcnt(12)
  v_mfma_f32_16x16x32_bf16 a[12:15], v[64:67], v[60:63], a[12:15]
  s_waitcnt lgkmcnt(10)
  ds_read_b64_tr_b16 v[92:93], v23 offset:16392
  v_mfma_f32_16x16x32_bf16 a[16:19], v[68:71], v[48:51], a[16:19]
  ds_read_b64_tr_b16 v[94:95], v23 offset:18440
  buffer_load_dwordx4 v17, s[4:7], s26 offen offset:3072 nt lds
  v_mfma_f32_16x16x32_bf16 a[20:23], v[68:71], v[52:55], a[20:23]
  s_add_u32 s29, s29, 0x4000
  s_and_b32 s29, s29, 0xffff
  ds_read_b64_tr_b16 v[96:97], v20 offset:16640
  v_mfma_f32_16x16x32_bf16 a[24:27], v[68:71], v[56:59], a[24:27]
  s_mov_b32 s26, s25
  v_mfma_f32_16x16x32_bf16 a[28:31], v[68:71], v[60:63], a[28:31]
  s_waitcnt lgkmcnt(11)
  ds_read_b64_tr_b16 v[98:99], v20 offset:18688
  v_mfma_f32_16x16x32_bf16 a[32:35], v[72:75], v[48:51], a[32:35]
  s_add_u32 m0, s65, 0x10000
  ds_read_b64_tr_b16 v[100:101], v20 offset:16648
  v_mfma_f32_16x16x32_bf16 a[36:39], v[72:75], v[52:55], a[36:39]
  ds_read_b64_tr_b16 v[102:103], v20 offset:18696
  buffer_load_dwordx4 v18, s[8:11], s27 offen offset:0 nt lds
  v_mfma_f32_16x16x32_bf16 a[40:43], v[72:75], v[56:59], a[40:43]
  v_mfma_f32_16x16x32_bf16 a[44:47], v[72:75], v[60:63], a[44:47]
  s_waitcnt lgkmcnt(12)
  ds_read_b64_tr_b16 v[104:105], v21 offset:16640
  v_mfma_f32_16x16x32_bf16 a[48:51], v[76:79], v[48:51], a[48:51]
  ds_read_b64_tr_b16 v[106:107], v21 offset:18688
  v_mfma_f32_16x16x32_bf16 a[52:55], v[76:79], v[52:55], a[52:55]
  ds_read_b64_tr_b16 v[108:109], v21 offset:16648
  v_mfma_f32_16x16x32_bf16 a[56:59], v[76:79], v[56:59], a[56:59]
  ds_read_b64_tr_b16 v[110:111], v21 offset:18696
  buffer_load_dwordx4 v19, s[8:11], s27 offen offset:1024 nt lds
  v_mfma_f32_16x16x32_bf16 a[60:63], v[76:79], v[60:63], a[60:63]
  s_waitcnt lgkmcnt(14)
  v_mfma_f32_16x16x32_bf16 a[64:67], v[80:83], v[48:51], a[64:67]
  ds_read_b64_tr_b16 v[112:113], v22 offset:16640
  v_mfma_f32_16x16x32_bf16 a[68:71], v[80:83], v[52:55], a[68:71]
  ds_read_b64_tr_b16 v[114:115], v22 offset:18688
  v_mfma_f32_16x16x32_bf16 a[72:75], v[80:83], v[56:59], a[72:75]
  ds_read_b64_tr_b16 v[116:117], v22 offset:16648
  buffer_load_dwordx4 v18, s[8:11], s27 offen offset:2048 nt lds
  v_mfma_f32_16x16x32_bf16 a[76:79], v[80:83], v[60:63], a[76:79]
  s_waitcnt lgkmcnt(15)
  v_mfma_f32_16x16x32_bf16 a[80:83], v[84:87], v[48:51], a[80:83]
  ds_read_b64_tr_b16 v[118:119], v22 offset:18696
  v_mfma_f32_16x16x32_bf16 a[84:87], v[84:87], v[52:55], a[84:87]
  ds_read_b64_tr_b16 v[120:121], v23 offset:16640
  v_mfma_f32_16x16x32_bf16 a[88:91], v[84:87], v[56:59], a[88:91]
  ds_read_b64_tr_b16 v[122:123], v23 offset:18688
  v_mfma_f32_16x16x32_bf16 a[92:95], v[84:87], v[60:63], a[92:95]
  s_waitcnt lgkmcnt(15)
  buffer_load_dwordx4 v19, s[8:11], s27 offen offset:3072 nt lds
  v_mfma_f32_16x16x32_bf16 a[96:99], v[88:91], v[48:51], a[96:99]
  s_add_u32 s65, s65, 0x4000
  s_and_b32 s65, s65, 0xffff
  ds_read_b64_tr_b16 v[124:125], v23 offset:16648
  v_mfma_f32_16x16x32_bf16 a[100:103], v[88:91], v[52:55], a[100:103]
  s_add_u32 s27, s27, 0x4000
  ds_read_b64_tr_b16 v[126:127], v23 offset:18696
  v_mfma_f32_16x16x32_bf16 a[104:107], v[88:91], v[56:59], a[104:107]
  v_mfma_f32_16x16x32_bf16 a[108:111], v[88:91], v[60:63], a[108:111]
  s_waitcnt lgkmcnt(15)
  v_mfma_f32_16x16x32_bf16 a[112:115], v[92:95], v[48:51], a[112:115]
  v_mfma_f32_16x16x32_bf16 a[116:119], v[92:95], v[52:55], a[116:119]
  v_mfma_f32_16x16x32_bf16 a[120:123], v[92:95], v[56:59], a[120:123]
  v_mfma_f32_16x16x32_bf16 a[124:127], v[92:95], v[60:63], a[124:127]
  s_waitcnt vmcnt(16) lgkmcnt(0)
  ds_add_u32 v30, a255
  v_mfma_f32_16x16x32_bf16 v[128:131], v[96:99], v[48:51], v[128:131]
  v_mfma_f32_16x16x32_bf16 v[132:135], v[96:99], v[52:55], v[132:135]
  v_xor_b32 v20, 0x8000, v20
  v_mfma_f32_16x16x32_bf16 v[136:139], v[96:99], v[56:59], v[136:139]
  v_xor_b32 v21, 0x8000, v21
  v_mfma_f32_16x16x32_bf16 v[140:143], v[96:99], v[60:63], v[140:143]
  v_xor_b32 v22, 0x8000, v22
  v_mfma_f32_16x16x32_bf16 v[144:147], v[100:103], v[48:51], v[144:147]
  v_xor_b32 v23, 0x8000, v23
  v_mfma_f32_16x16x32_bf16 v[148:151], v[100:103], v[52:55], v[148:151]
  v_xor_b32 v24, 0x8000, v24
  v_mfma_f32_16x16x32_bf16 v[152:155], v[100:103], v[56:59], v[152:155]
  v_mfma_f32_16x16x32_bf16 v[156:159], v[100:103], v[60:63], v[156:159]
  ds_read_b32 v0, v30
  v_mfma_f32_16x16x32_bf16 v[160:163], v[104:107], v[48:51], v[160:163]
  v_mfma_f32_16x16x32_bf16 v[164:167], v[104:107], v[52:55], v[164:167]
  v_mfma_f32_16x16x32_bf16 v[168:171], v[104:107], v[56:59], v[168:171]
  v_mfma_f32_16x16x32_bf16 v[172:175], v[104:107], v[60:63], v[172:175]
  v_mfma_f32_16x16x32_bf16 v[176:179], v[108:111], v[48:51], v[176:179]
  v_mfma_f32_16x16x32_bf16 v[180:183], v[108:111], v[52:55], v[180:183]
  s_waitcnt lgkmcnt(0)
  v_cmp_gt_u32 vcc, s68, v0
  v_mfma_f32_16x16x32_bf16 v[184:187], v[108:111], v[56:59], v[184:187]
  s_cbranch_vccnz L_spin3
L_spin3_ret:
  s_add_u32 s68, s68, 4
  v_mfma_f32_16x16x32_bf16 v[188:191], v[108:111], v[60:63], v[188:191]
  v_mfma_f32_16x16x32_bf16 v[192:195], v[112:115], v[48:51], v[192:195]
  ds_read_b128 v[32:35], v24 offset:0
  v_mfma_f32_16x16x32_bf16 v[196:199], v[112:115], v[52:55], v[196:199]
  ds_read_b128 v[36:39], v24 offset:1024
  ds_read_b64_tr_b16 v[64:65], v20 offset:0
  v_mfma_f32_16x16x32_bf16 v[200:203], v[112:115], v[56:59], v[200:203]
  ds_read_b128 v[40:43], v24 offset:2048
  ds_read_b64_tr_b16 v[66:67], v20 offset:2048
  v_mfma_f32_16x16x32_bf16 v[204:207], v[112:115], v[60:63], v[204:207]
  ds_read_b128 v[44:47], v24 offset:3072
  ds_read_b64_tr_b16 v[68:69], v20 offset:8
  v_mfma_f32_16x16x32_bf16 v[208:211], v[116:119], v[48:51], v[208:211]
  ds_read_b64_tr_b16 v[70:71], v20 offset:2056
  v_mfma_f32_16x16x32_bf16 v[212:215], v[116:119], v[52:55], v[212:215]
  s_mov_b32 m0, s29
  v_mfma_f32_16x16x32_bf16 v[216:219], v[116:119], v[56:59], v[216:219]
  ds_read_b64_tr_b16 v[72:73], v21 offset:0
  buffer_load_dwordx4 v14, s[4:7], s26 offen offset:0 nt lds
  v_mfma_f32_16x16x32_bf16 v[220:223], v[116:119], v[60:63], v[220:223]
  ds_read_b64_tr_b16 v[74:75], v21 offset:2048
  v_mfma_f32_16x16x32_bf16 v[224:227], v[120:123], v[48:51], v[224:227]
  ds_read_b64_tr_b16 v[76:77], v21 offset:8
  v_mfma_f32_16x16x32_bf16 v[228:231], v[120:123], v[52:55], v[228:231]
  v_mfma_f32_16x16x32_bf16 v[232:235], v[120:123], v[56:59], v[232:235]
  ds_read_b64_tr_b16 v[78:79], v21 offset:2056
  v_mfma_f32_16x16x32_bf16 v[236:239], v[120:123], v[60:63], v[236:239]
  ds_read_b64_tr_b16 v[80:81], v22 offset:0
  buffer_load_dwordx4 v15, s[4:7], s26 offen offset:1024 nt lds
  v_mfma_f32_16x16x32_bf16 v[240:243], v[124:127], v[48:51], v[240:243]
  ds_read_b64_tr_b16 v[82:83], v22 offset:2048
  v_mfma_f32_16x16x32_bf16 v[244:247], v[124:127], v[52:55], v[244:247]
  v_mfma_f32_16x16x32_bf16 v[248:251], v[124:127], v[56:59], v[248:251]
  ds_read_b64_tr_b16 v[84:85], v22 offset:8
  v_mfma_f32_16x16x32_bf16 v[252:255], v[124:127], v[60:63], v[252:255]
  s_waitcnt lgkmcnt(10)
  ds_read_b64_tr_b16 v[86:87], v22 offset:2056
  buffer_load_dwordx4 v16, s[4:7], s26 offen offset:2048 nt lds
  v_mfma_f32_16x16x32_bf16 a[0:3], v[64:67], v[32:35], a[0:3]
  ds_read_b64_tr_b16 v[88:89], v23 offset:0
  v_mfma_f32_16x16x32_bf16 a[4:7], v[64:67], v[36:39], a[4:7]
  ds_read_b64_tr_b16 v[90:91], v23 offset:2048
  v_mfma_f32_16x16x32_bf16 a[8:11], v[64:67], v[40:43], a[8:11]
  s_waitcnt lgkmcnt(12)
  v_mfma_f32_16x16x32_bf16 a[12:15], v[64:67], v[44:47], a[12:15]
  s_waitcnt lgkmcnt(10)
  ds_read_b64_tr_b16 v[92:93], v23 offset:8
  v_mfma_f32_16x16x32_bf16 a[16:19], v[68:71], v[32:35], a[16:19]
  ds_read_b64_tr_b16 v[94:95], v23 offset:2056
  buffer_load_dwordx4 v17, s[4:7], s26 offen offset:3072 nt lds
  v_mfma_f32_16x16x32_bf16 a[20:23], v[68:71], v[36:39], a[20:23]
  s_add_u32 s29, s29, 0x4000
  s_and_b32 s29, s29, 0xffff
  ds_read_b64_tr_b16 v[96:97], v20 offset:256
  v_mfma_f32_16x16x32_bf16 a[24:27], v[68:71], v[40:43], a[24:27]
  s_add_u32 s26, s26, 0x4000
  v_mfma_f32_16x16x32_bf16 a[28:31], v[68:71], v[44:47], a[28:31]
  s_waitcnt lgkmcnt(11)
  ds_read_b64_tr_b16 v[98:99], v20 offset:2304
  v_mfma_f32_16x16x32_bf16 a[32:35], v[72:75], v[32:35], a[32:35]
  s_add_u32 m0, s65, 0x10000
  ds_read_b64_tr_b16 v[100:101], v20 offset:264
  v_mfma_f32_16x16x32_bf16 a[36:39], v[72:75], v[36:39], a[36:39]
  ds_read_b64_tr_b16 v[102:103], v20 offset:2312
  buffer_load_dwordx4 v18, s[8:11], s27 offen offset:0 nt lds
  v_mfma_f32_16x16x32_bf16 a[40:43], v[72:75], v[40:43], a[40:43]
  v_mfma_f32_16x16x32_bf16 a[44:47], v[72:75], v[44:47], a[44:47]
  s_waitcnt lgkmcnt(12)
  ds_read_b64_tr_b16 v[104:105], v21 offset:256
  v_mfma_f32_16x16x32_bf16 a[48:51], v[76:79], v[32:35], a[48:51]
  ds_read_b64_tr_b16 v[106:107], v21 offset:2304
  v_mfma_f32_16x16x32_bf16 a[52:55], v[76:79], v[36:39], a[52:55]
  ds_read_b64_tr_b16 v[108:109], v21 offset:264
  v_mfma_f32_16x16x32_bf16 a[56:59], v[76:79], v[40:43], a[56:59]
  ds_read_b64_tr_b16 v[110:111], v21 offset:2312
  buffer_load_dwordx4 v19, s[8:11], s27 offen offset:1024 nt lds
  v_mfma_f32_16x16x32_bf16 a[60:63], v[76:79], v[44:47], a[60:63]
  s_waitcnt lgkmcnt(14)
  v_mfma_f32_16x16x32_bf16 a[64:67], v[80:83], v[32:35], a[64:67]
  ds_read_b64_tr_b16 v[112:113], v22 offset:256
  v_mfma_f32_16x16x32_bf16 a[68:71], v[80:83], v[36:39], a[68:71]
  ds_read_b64_tr_b16 v[114:115], v22 offset:2304
  v_mfma_f32_16x16x32_bf16 a[72:75], v[80:83], v[40:43], a[72:75]
  ds_read_b64_tr_b16 v[116:117], v22 offset:264
  buffer_load_dwordx4 v18, s[8:11], s27 offen offset:2048 nt lds
  v_mfma_f32_16x16x32_bf16 a[76:79], v[80:83], v[44:47], a[76:79]
  s_waitcnt lgkmcnt(15)
  v_mfma_f32_16x16x32_bf16 a[80:83], v[84:87], v[32:35], a[80:83]
  ds_read_b64_tr_b16 v[118:119], v22 offset:2312
  v_mfma_f32_16x16x32_bf16 a[84:87], v[84:87], v[36:39], a[84:87]
  ds_read_b64_tr_b16 v[120:121], v23 offset:256
  v_mfma_f32_16x16x32_bf16 a[88:91], v[84:87], v[40:43], a[88:91]
  ds_read_b64_tr_b16 v[122:123], v23 offset:2304
  v_mfma_f32_16x16x32_bf16 a[92:95], v[84:87], v[44:47], a[92:95]
  s_waitcnt lgkmcnt(15)
  buffer_load_dwordx4 v19, s[8:11], s27 offen offset:3072 nt lds
  v_mfma_f32_16x16x32_bf16 a[96:99], v[88:91], v[32:35], a[96:99]
  s_add_u32 s65, s65, 0x4000
  s_and_b32 s65, s65, 0xffff
  ds_read_b64_tr_b16 v[124:125], v23 offset:264
  v_mfma_f32_16x16x32_bf16 a[100:103], v[88:91], v[36:39], a[100:103]
  s_add_u32 s27, s27, 0x4000
  ds_read_b64_tr_b16 v[126:127], v23 offset:2312
  v_mfma_f32_16x16x32_bf16 a[104:107], v[88:91], v[40:43], a[104:107]
  v_mfma_f32_16x16x32_bf16 a[108:111], v[88:91], v[44:47], a[108:111]
  s_waitcnt lgkmcnt(15)
  v_mfma_f32_16x16x32_bf16 a[112:115], v[92:95], v[32:35], a[112:115]
  v_mfma_f32_16x16x32_bf16 a[116:119], v[92:95], v[36:39], a[116:119]
  v_mfma_f32_16x16x32_bf16 a[120:123], v[92:95], v[40:43], a[120:123]
  v_mfma_f32_16x16x32_bf16 a[124:127], v[92:95], v[44:47], a[124:127]
  s_waitcnt vmcnt(16) lgkmcnt(0)
  ds_add_u32 v30, a255
  v_mfma_f32_16x16x32_bf16 v[128:131], v[96:99], v[32:35], v[128:131]
  v_mfma_f32_16x16x32_bf16 v[132:135], v[96:99], v[36:39], v[132:135]
  v_mfma_f32_16x16x32_bf16 v[136:139], v[96:99], v[40:43], v[136:139]
  v_mfma_f32_16x16x32_bf16 v[140:143], v[96:99], v[44:47], v[140:143]
  v_mfma_f32_16x16x32_bf16 v[144:147], v[100:103], v[32:35], v[144:147]
  v_mfma_f32_16x16x32_bf16 v[148:151], v[100:103], v[36:39], v[148:151]
  v_mfma_f32_16x16x32_bf16 v[152:155], v[100:103], v[40:43], v[152:155]
  v_mfma_f32_16x16x32_bf16 v[156:159], v[100:103], v[44:47], v[156:159]
  ds_read_b32 v0, v30
  v_mfma_f32_16x16x32_bf16 v[160:163], v[104:107], v[32:35], v[160:163]
  v_mfma_f32_16x16x32_bf16 v[164:167], v[104:107], v[36:39], v[164:167]
  v_mfma_f32_16x16x32_bf16 v[168:171], v[104:107], v[40:43], v[168:171]
  v_mfma_f32_16x16x32_bf16 v[172:175], v[104:107], v[44:47], v[172:175]
  v_mfma_f32_16x16x32_bf16 v[176:179], v[108:111], v[32:35], v[176:179]
  v_mfma_f32_16x16x32_bf16 v[180:183], v[108:111], v[36:39], v[180:183]
  s_waitcnt lgkmcnt(0)
  v_cmp_gt_u32 vcc, s68, v0
  v_mfma_f32_16x16x32_bf16 v[184:187], v[108:111], v[40:43], v[184:187]
  s_cbranch_vccnz L_spin4
L_spin4_ret:
  s_add_u32 s68, s68, 4
  v_mfma_f32_16x16x32_bf16 v[188:191], v[108:111], v[44:47], v[188:191]
  v_mfma_f32_16x16x32_bf16 v[192:195], v[112:115], v[32:35], v[192:195]
  ds_read_b128 v[48:51], v24 offset:16384
  v_mfma_f32_16x16x32_bf16 v[196:199], v[112:115], v[36:39], v[196:199]
  ds_read_b128 v[52:55], v24 offset:17408
  ds_read_b64_tr_b16 v[64:65], v20 offset:16384
  v_mfma_f32_16x16x32_bf16 v[200:203], v[112:115], v[40:43], v[200:203]
  ds_read_b128 v[56:59], v24 offset:18432
  ds_read_b64_tr_b16 v[66:67], v20 offset:18432
  v_mfma_f32_16x16x32_bf16 v[204:207], v[112:115], v[44:47], v[204:207]
  ds_read_b128 v[60:63], v24 offset:19456
  ds_read_b64_tr_b16 v[68:69], v20 offset:16392
  v_mfma_f32_16x16x32_bf16 v[208:211], v[116:119], v[32:35], v[208:211]
  ds_read_b64_tr_b16 v[70:71], v20 offset:18440
  v_mfma_f32_16x16x32_bf16 v[212:215], v[116:119], v[36:39], v[212:215]
  s_mov_b32 m0, s29
  v_mfma_f32_16x16x32_bf16 v[216:219], v[116:119], v[40:43], v[216:219]
  ds_read_b64_tr_b16 v[72:73], v21 offset:16384
  buffer_load_dwordx4 v14, s[4:7], s26 offen offset:0 nt lds
  v_mfma_f32_16x16x32_bf16 v[220:223], v[116:119], v[44:47], v[220:223]
  ds_read_b64_tr_b16 v[74:75], v21 offset:18432
  v_mfma_f32_16x16x32_bf16 v[224:227], v[120:123], v[32:35], v[224:227]
  ds_read_b64_tr_b16 v[76:77], v21 offset:16392
  v_mfma_f32_16x16x32_bf16 v[228:231], v[120:123], v[36:39], v[228:231]
  v_mfma_f32_16x16x32_bf16 v[232:235], v[120:123], v[40:43], v[232:235]
  ds_read_b64_tr_b16 v[78:79], v21 offset:18440
  v_mfma_f32_16x16x32_bf16 v[236:239], v[120:123], v[44:47], v[236:239]
  ds_read_b64_tr_b16 v[80:81], v22 offset:16384
  buffer_load_dwordx4 v15, s[4:7], s26 offen offset:1024 nt lds
  v_mfma_f32_16x16x32_bf16 v[240:243], v[124:127], v[32:35], v[240:243]
  ds_read_b64_tr_b16 v[82:83], v22 offset:18432
  v_mfma_f32_16x16x32_bf16 v[244:247], v[124:127], v[36:39], v[244:247]
  v_mfma_f32_16x16x32_bf16 v[248:251], v[124:127], v[40:43], v[248:251]
  ds_read_b64_tr_b16 v[84:85], v22 offset:16392
  v_mfma_f32_16x16x32_bf16 v[252:255], v[124:127], v[44:47], v[252:255]
  s_waitcnt lgkmcnt(10)
  ds_read_b64_tr_b16 v[86:87], v22 offset:18440
  buffer_load_dwordx4 v16, s[4:7], s26 offen offset:2048 nt lds
  v_mfma_f32_16x16x32_bf16 a[0:3], v[64:67], v[48:51], a[0:3]
  ds_read_b64_tr_b16 v[88:89], v23 offset:16384
  v_mfma_f32_16x16x32_bf16 a[4:7], v[64:67], v[52:55], a[4:7]
  ds_read_b64_tr_b16 v[90:91], v23 offset:18432
  v_mfma_f32_16x16x32_bf16 a[8:11], v[64:67], v[56:59], a[8:11]
  s_waitcnt lgkmcnt(12)
  v_mfma_f32_16x16x32_bf16 a[12:15], v[64:67], v[60:63], a[12:15]
  s_waitcnt lgkmcnt(10)
  ds_read_b64_tr_b16 v[92:93], v23 offset:16392
  v_mfma_f32_16x16x32_bf16 a[16:19], v[68:71], v[48:51], a[16:19]
  ds_read_b64_tr_b16 v[94:95], v23 offset:18440
  buffer_load_dwordx4 v17, s[4:7], s26 offen offset:3072 nt lds
  v_mfma_f32_16x16x32_bf16 a[20:23], v[68:71], v[52:55], a[20:23]
  s_add_u32 s29, s29, 0x4000
  s_and_b32 s29, s29, 0xffff
  ds_read_b64_tr_b16 v[96:97], v20 offset:16640
  v_mfma_f32_16x16x32_bf16 a[24:27], v[68:71], v[56:59], a[24:27]
  s_add_u32 s26, s26, 0x4000
  v_mfma_f32_16x16x32_bf16 a[28:31], v[68:71], v[60:63], a[28:31]
  s_waitcnt lgkmcnt(11)
  ds_read_b64_tr_b16 v[98:99], v20 offset:18688
  v_mfma_f32_16x16x32_bf16 a[32:35], v[72:75], v[48:51], a[32:35]
  s_add_u32 m0, s65, 0x10000
  ds_read_b64_tr_b16 v[100:101], v20 offset:16648
  v_mfma_f32_16x16x32_bf16 a[36:39], v[72:75], v[52:55], a[36:39]
  ds_read_b64_tr_b16 v[102:103], v20 offset:18696
  buffer_load_dwordx4 v18, s[8:11], s27 offen offset:0 nt lds
  v_mfma_f32_16x16x32_bf16 a[40:43], v[72:75], v[56:59], a[40:43]
  v_mfma_f32_16x16x32_bf16 a[44:47], v[72:75], v[60:63], a[44:47]
  s_waitcnt lgkmcnt(12)
  ds_read_b64_tr_b16 v[104:105], v21 offset:16640
  v_mfma_f32_16x16x32_bf16 a[48:51], v[76:79], v[48:51], a[48:51]
  ds_read_b64_tr_b16 v[106:107], v21 offset:18688
  v_mfma_f32_16x16x32_bf16 a[52:55], v[76:79], v[52:55], a[52:55]
  ds_read_b64_tr_b16 v[108:109], v21 offset:16648
  v_mfma_f32_16x16x32_bf16 a[56:59], v[76:79], v[56:59], a[56:59]
  ds_read_b64_tr_b16 v[110:111], v21 offset:18696
  buffer_load_dwordx4 v19, s[8:11], s27 offen offset:1024 nt lds
  v_mfma_f32_16x16x32_bf16 a[60:63], v[76:79], v[60:63], a[60:63]
  s_waitcnt lgkmcnt(14)
  v_mfma_f32_16x16x32_bf16 a[64:67], v[80:83], v[48:51], a[64:67]
  ds_read_b64_tr_b16 v[112:113], v22 offset:16640
  v_mfma_f32_16x16x32_bf16 a[68:71], v[80:83], v[52:55], a[68:71]
  ds_read_b64_tr_b16 v[114:115], v22 offset:18688
  v_mfma_f32_16x16x32_bf16 a[72:75], v[80:83], v[56:59], a[72:75]
  ds_read_b64_tr_b16 v[116:117], v22 offset:16648
  buffer_load_dwordx4 v18, s[8:11], s27 offen offset:2048 nt lds
  v_mfma_f32_16x16x32_bf16 a[76:79], v[80:83], v[60:63], a[76:79]
  s_waitcnt lgkmcnt(15)
  v_mfma_f32_16x16x32_bf16 a[80:83], v[84:87], v[48:51], a[80:83]
  ds_read_b64_tr_b16 v[118:119], v22 offset:18696
  v_mfma_f32_16x16x32_bf16 a[84:87], v[84:87], v[52:55], a[84:87]
  ds_read_b64_tr_b16 v[120:121], v23 offset:16640
  v_mfma_f32_16x16x32_bf16 a[88:91], v[84:87], v[56:59], a[88:91]
  ds_read_b64_tr_b16 v[122:123], v23 offset:18688
  v_mfma_f32_16x16x32_bf16 a[92:95], v[84:87], v[60:63], a[92:95]
  s_waitcnt lgkmcnt(15)
  buffer_load_dwordx4 v19, s[8:11], s27 offen offset:3072 nt lds
  v_mfma_f32_16x16x32_bf16 a[96:99], v[88:91], v[48:51], a[96:99]
  s_add_u32 s65, s65, 0x4000
  s_and_b32 s65, s65, 0xffff
  ds_read_b64_tr_b16 v[124:125], v23 offset:16648
  v_mfma_f32_16x16x32_bf16 a[100:103], v[88:91], v[52:55], a[100:103]
  s_add_u32 s27, s27, 0x4000
  ds_read_b64_tr_b16 v[126:127], v23 offset:18696
  v_mfma_f32_16x16x32_bf16 a[104:107], v[88:91], v[56:59], a[104:107]
  v_mfma_f32_16x16x32_bf16 a[108:111], v[88:91], v[60:63], a[108:111]
  s_waitcnt lgkmcnt(15)
  v_mfma_f32_16x16x32_bf16 a[112:115], v[92:95], v[48:51], a[112:115]
  v_mfma_f32_16x16x32_bf16 a[116:119], v[92:95], v[52:55], a[116:119]
  v_mfma_f32_16x16x32_bf16 a[120:123], v[92:95], v[56:59], a[120:123]
  v_mfma_f32_16x16x32_bf16 a[124:127], v[92:95], v[60:63], a[124:127]
  s_waitcnt vmcnt(16) lgkmcnt(0)
  ds_add_u32 v30, a255
  v_mfma_f32_16x16x32_bf16 v[128:131], v[96:99], v[48:51], v[128:131]
  v_mfma_f32_16x16x32_bf16 v[132:135], v[96:99], v[52:55], v[132:135]
  v_mfma_f32_16x16x32_bf16 v[136:139], v[96:99], v[56:59], v[136:139]
  v_mfma_f32_16x16x32_bf16 v[140:143], v[96:99], v[60:63], v[140:143]
  v_mfma_f32_16x16x32_bf16 v[144:147], v[100:103], v[48:51], v[144:147]
  v_mfma_f32_16x16x32_bf16 v[148:151], v[100:103], v[52:55], v[148:151]
  v_mfma_f32_16x16x32_bf16 v[152:155], v[100:103], v[56:59], v[152:155]
  v_mfma_f32_16x16x32_bf16 v[156:159], v[100:103], v[60:63], v[156:159]
  ds_read_b32 v0, v30
  v_mfma_f32_16x16x32_bf16 v[160:163], v[104:107], v[48:51], v[160:163]
  v_mfma_f32_16x16x32_bf16 v[164:167], v[104:107], v[52:55], v[164:167]
  v_mfma_f32_16x16x32_bf16 v[168:171], v[104:107], v[56:59], v[168:171]
  v_mfma_f32_16x16x32_bf16 v[172:175], v[104:107], v[60:63], v[172:175]
  v_mfma_f32_16x16x32_bf16 v[176:179], v[108:111], v[48:51], v[176:179]
  v_mfma_f32_16x16x32_bf16 v[180:183], v[108:111], v[52:55], v[180:183]
  s_waitcnt lgkmcnt(0)
  v_cmp_gt_u32 vcc, s68, v0
  v_mfma_f32_16x16x32_bf16 v[184:187], v[108:111], v[56:59], v[184:187]
  s_cbranch_vccnz L_spin5
L_spin5_ret:
  s_add_u32 s68, s68, 4
  v_mfma_f32_16x16x32_bf16 v[188:191], v[108:111], v[60:63], v[188:191]
  v_mfma_f32_16x16x32_bf16 v[192:195], v[112:115], v[48:51], v[192:195]
  v_mfma_f32_16x16x32_bf16 v[196:199], v[112:115], v[52:55], v[196:199]
  v_mfma_f32_16x16x32_bf16 v[200:203], v[112:115], v[56:59], v[200:203]
  v_mfma_f32_16x16x32_bf16 v[204:207], v[112:115], v[60:63], v[204:207]
  v_mfma_f32_16x16x32_bf16 v[208:211], v[116:119], v[48:51], v[208:211]
  v_mfma_f32_16x16x32_bf16 v[212:215], v[116:119], v[52:55], v[212:215]
  v_mfma_f32_16x16x32_bf16 v[216:219], v[116:119], v[56:59], v[216:219]
  v_mfma_f32_16x16x32_bf16 v[220:223], v[116:119], v[60:63], v[220:223]
  v_mfma_f32_16x16x32_bf16 v[224:227], v[120:123], v[48:51], v[224:227]
  v_mfma_f32_16x16x32_bf16 v[228:231], v[120:123], v[52:55], v[228:231]
  v_mfma_f32_16x16x32_bf16 v[232:235], v[120:123], v[56:59], v[232:235]
  v_mfma_f32_16x16x32_bf16 v[236:239], v[120:123], v[60:63], v[236:239]
  v_mfma_f32_16x16x32_bf16 v[240:243], v[124:127], v[48:51], v[240:243]
  v_mfma_f32_16x16x32_bf16 v[244:247], v[124:127], v[52:55], v[244:247]
  v_mfma_f32_16x16x32_bf16 v[248:251], v[124:127], v[56:59], v[248:251]
  v_mfma_f32_16x16x32_bf16 v[252:255], v[124:127], v[60:63], v[252:255]
  s_mov_b32 m0, s29
  s_nop 0
  buffer_load_dwordx4 v14, s[4:7], s26 offen offset:0 nt lds
  buffer_load_dwordx4 v15, s[4:7], s26 offen offset:1024 nt lds
  buffer_load_dwordx4 v16, s[4:7], s26 offen offset:2048 nt lds
  buffer_load_dwordx4 v17, s[4:7], s26 offen offset:3072 nt lds
  s_add_u32 s29, s29, 0x4000
  s_and_b32 s29, s29, 0xffff
  s_add_u32 s26, s26, 0x4000
  s_add_u32 s29, s29, 0x4000
  s_and_b32 s29, s29, 0xffff
  s_add_u32 s26, s25, 0x10000
  v_mov_b32 v20, 0x3e0293ee
  v_mov_b32 v21, 0x3e0293ee
  v_mov_b32 v22, 0x3f803f80
  v_accvgpr_write_b32 a192, v22
  v_accvgpr_write_b32 a193, v22
  v_accvgpr_write_b32 a194, v22
  v_accvgpr_write_b32 a195, v22
  v_accvgpr_read_b32 v64, a0
  v_accvgpr_read_b32 v65, a1
  v_accvgpr_read_b32 v66, a2
  v_accvgpr_read_b32 v67, a3
  v_accvgpr_read_b32 v68, a16
  v_accvgpr_read_b32 v69, a17
  v_accvgpr_read_b32 v70, a18
  v_accvgpr_read_b32 v71, a19
  v_accvgpr_read_b32 v72, a4
  v_accvgpr_read_b32 v73, a5
  v_accvgpr_read_b32 v74, a6
  v_accvgpr_read_b32 v75, a7
  v_accvgpr_read_b32 v76, a20
  v_accvgpr_read_b32 v77, a21
  v_accvgpr_read_b32 v78, a22
  v_accvgpr_read_b32 v79, a23
  v_accvgpr_read_b32 v80, a8
  v_accvgpr_read_b32 v81, a9
  v_accvgpr_read_b32 v82, a10
  v_accvgpr_read_b32 v83, a11
  v_accvgpr_read_b32 v84, a24
  v_accvgpr_read_b32 v85, a25
  v_accvgpr_read_b32 v86, a26
  v_accvgpr_read_b32 v87, a27
  v_accvgpr_read_b32 v88, a12
  v_accvgpr_read_b32 v89, a13
  v_accvgpr_read_b32 v90, a14
  v_accvgpr_read_b32 v91, a15
  v_accvgpr_read_b32 v92, a28
  v_accvgpr_read_b32 v93, a29
  v_accvgpr_read_b32 v94, a30
  v_accvgpr_read_b32 v95, a31
  v_pk_mul_f32 v[64:65], v[64:65], v[20:21]
  v_pk_mul_f32 v[66:67], v[66:67], v[20:21]
  v_pk_mul_f32 v[68:69], v[68:69], v[20:21]
  v_pk_mul_f32 v[70:71], v[70:71], v[20:21]
  v_pk_mul_f32 v[72:73], v[72:73], v[20:21]
  v_pk_mul_f32 v[74:75], v[74:75], v[20:21]
  v_pk_mul_f32 v[76:77], v[76:77], v[20:21]
  v_pk_mul_f32 v[78:79], v[78:79], v[20:21]
  v_pk_mul_f32 v[80:81], v[80:81], v[20:21]
  v_pk_mul_f32 v[82:83], v[82:83], v[20:21]
  v_pk_mul_f32 v[84:85], v[84:85], v[20:21]
  v_pk_mul_f32 v[86:87], v[86:87], v[20:21]
  v_pk_mul_f32 v[88:89], v[88:89], v[20:21]
  v_pk_mul_f32 v[90:91], v[90:91], v[20:21]
  v_pk_mul_f32 v[92:93], v[92:93], v[20:21]
  v_pk_mul_f32 v[94:95], v[94:95], v[20:21]
  v_cvt_pk_bf16_f32 v96, v64, v65
  v_cvt_pk_bf16_f32 v97, v66, v67
  v_cvt_pk_bf16_f32 v98, v68, v69
  v_cvt_pk_bf16_f32 v99, v70, v71
  v_cvt_pk_bf16_f32 v100, v72, v73
  v_cvt_pk_bf16_f32 v101, v74, v75
  v_cvt_pk_bf16_f32 v102, v76, v77
  v_cvt_pk_bf16_f32 v103, v78, v79
  v_cvt_pk_bf16_f32 v104, v80, v81
  v_cvt_pk_bf16_f32 v105, v82, v83
  v_cvt_pk_bf16_f32 v106, v84, v85
  v_cvt_pk_bf16_f32 v107, v86, v87
  v_cvt_pk_bf16_f32 v108, v88, v89
  v_cvt_pk_bf16_f32 v109, v90, v91
  v_cvt_pk_bf16_f32 v110, v92, v93
  v_cvt_pk_bf16_f32 v111, v94, v95
  v_accvgpr_write_b32 a0, v96
  v_accvgpr_write_b32 a1, v97
  v_accvgpr_write_b32 a2, v98
  v_accvgpr_write_b32 a3, v99
  v_accvgpr_write_b32 a4, v100
  v_accvgpr_write_b32 a5, v101
  v_accvgpr_write_b32 a6, v102
  v_accvgpr_write_b32 a7, v103
  v_accvgpr_write_b32 a8, v104
  v_accvgpr_write_b32 a9, v105
  v_accvgpr_write_b32 a10, v106
  v_accvgpr_write_b32 a11, v107
  v_accvgpr_write_b32 a12, v108
  v_accvgpr_write_b32 a13, v109
  v_accvgpr_write_b32 a14, v110
  v_accvgpr_write_b32 a15, v111
  v_accvgpr_read_b32 v64, a32
  v_accvgpr_read_b32 v65, a33
  v_accvgpr_read_b32 v66, a34
  v_accvgpr_read_b32 v67, a35
  v_accvgpr_read_b32 v68, a48
  v_accvgpr_read_b32 v69, a49
  v_accvgpr_read_b32 v70, a50
  v_accvgpr_read_b32 v71, a51
  v_accvgpr_read_b32 v72, a36
  v_accvgpr_read_b32 v73, a37
  v_accvgpr_read_b32 v74, a38
  v_accvgpr_read_b32 v75, a39
  v_accvgpr_read_b32 v76, a52
  v_accvgpr_read_b32 v77, a53
  v_accvgpr_read_b32 v78, a54
  v_accvgpr_read_b32 v79, a55
  v_accvgpr_read_b32 v80, a40
  v_accvgpr_read_b32 v81, a41
  v_accvgpr_read_b32 v82, a42
  v_accvgpr_read_b32 v83, a43
  v_accvgpr_read_b32 v84, a56
  v_accvgpr_read_b32 v85, a57
  v_accvgpr_read_b32 v86, a58
  v_accvgpr_read_b32 v87, a59
  v_accvgpr_read_b32 v88, a44
  v_accvgpr_read_b32 v89, a45
  v_accvgpr_read_b32 v90, a46
  v_accvgpr_read_b32 v91, a47
  v_accvgpr_read_b32 v92, a60
  v_accvgpr_read_b32 v93, a61
  v_accvgpr_read_b32 v94, a62
  v_accvgpr_read_b32 v95, a63
  v_pk_mul_f32 v[64:65], v[64:65], v[20:21]
  v_pk_mul_f32 v[66:67], v[66:67], v[20:21]
  v_pk_mul_f32 v[68:69], v[68:69], v[20:21]
  v_pk_mul_f32 v[70:71], v[70:71], v[20:21]
  v_pk_mul_f32 v[72:73], v[72:73], v[20:21]
  v_pk_mul_f32 v[74:75], v[74:75], v[20:21]
  v_pk_mul_f32 v[76:77], v[76:77], v[20:21]
  v_pk_mul_f32 v[78:79], v[78:79], v[20:21]
  v_pk_mul_f32 v[80:81], v[80:81], v[20:21]
  v_pk_mul_f32 v[82:83], v[82:83], v[20:21]
  v_pk_mul_f32 v[84:85], v[84:85], v[20:21]
  v_pk_mul_f32 v[86:87], v[86:87], v[20:21]
  v_pk_mul_f32 v[88:89], v[88:89], v[20:21]
  v_pk_mul_f32 v[90:91], v[90:91], v[20:21]
  v_pk_mul_f32 v[92:93], v[92:93], v[20:21]
  v_pk_mul_f32 v[94:95], v[94:95], v[20:21]
  v_cvt_pk_bf16_f32 v96, v64, v65
  v_cvt_pk_bf16_f32 v97, v66, v67
  v_cvt_pk_bf16_f32 v98, v68, v69
  v_cvt_pk_bf16_f32 v99, v70, v71
  v_cvt_pk_bf16_f32 v100, v72, v73
  v_cvt_pk_bf16_f32 v101, v74, v75
  v_cvt_pk_bf16_f32 v102, v76, v77
  v_cvt_pk_bf16_f32 v103, v78, v79
  v_cvt_pk_bf16_f32 v104, v80, v81
  v_cvt_pk_bf16_f32 v105, v82, v83
  v_cvt_pk_bf16_f32 v106, v84, v85
  v_cvt_pk_bf16_f32 v107, v86, v87
  v_cvt_pk_bf16_f32 v108, v88, v89
  v_cvt_pk_bf16_f32 v109, v90, v91
  v_cvt_pk_bf16_f32 v110, v92, v93
  v_cvt_pk_bf16_f32 v111, v94, v95
  v_accvgpr_write_b32 a16, v96
  v_accvgpr_write_b32 a17, v97
  v_accvgpr_write_b32 a18, v98
  v_accvgpr_write_b32 a19, v99
  v_accvgpr_write_b32 a20, v100
  v_accvgpr_write_b32 a21, v101
  v_accvgpr_write_b32 a22, v102
  v_accvgpr_write_b32 a23, v103
  v_accvgpr_write_b32 a24, v104
  v_accvgpr_write_b32 a25, v105
  v_accvgpr_write_b32 a26, v106
  v_accvgpr_write_b32 a27, v107
  v_accvgpr_write_b32 a28, v108
  v_accvgpr_write_b32 a29, v109
  v_accvgpr_write_b32 a30, v110
  v_accvgpr_write_b32 a31, v111
  v_accvgpr_read_b32 v64, a64
  v_accvgpr_read_b32 v65, a65
  v_accvgpr_read_b32 v66, a66
  v_accvgpr_read_b32 v67, a67
  v_accvgpr_read_b32 v68, a80
  v_accvgpr_read_b32 v69, a81
  v_accvgpr_read_b32 v70, a82
  v_accvgpr_read_b32 v71, a83
  v_accvgpr_read_b32 v72, a68
  v_accvgpr_read_b32 v73, a69
  v_accvgpr_read_b32 v74, a70
  v_accvgpr_read_b32 v75, a71
  v_accvgpr_read_b32 v76, a84
  v_accvgpr_read_b32 v77, a85
  v_accvgpr_read_b32 v78, a86
  v_accvgpr_read_b32 v79, a87
  v_accvgpr_read_b32 v80, a72
  v_accvgpr_read_b32 v81, a73
  v_accvgpr_read_b32 v82, a74
  v_accvgpr_read_b32 v83, a75
  v_accvgpr_read_b32 v84, a88
  v_accvgpr_read_b32 v85, a89
  v_accvgpr_read_b32 v86, a90
  v_accvgpr_read_b32 v87, a91
  v_accvgpr_read_b32 v88, a76
  v_accvgpr_read_b32 v89, a77
  v_accvgpr_read_b32 v90, a78
  v_accvgpr_read_b32 v91, a79
  v_accvgpr_read_b32 v92, a92
  v_accvgpr_read_b32 v93, a93
  v_accvgpr_read_b32 v94, a94
  v_accvgpr_read_b32 v95, a95
  v_pk_mul_f32 v[64:65], v[64:65], v[20:21]
  v_pk_mul_f32 v[66:67], v[66:67], v[20:21]
  v_pk_mul_f32 v[68:69], v[68:69], v[20:21]
  v_pk_mul_f32 v[70:71], v[70:71], v[20:21]
  v_pk_mul_f32 v[72:73], v[72:73], v[20:21]
  v_pk_mul_f32 v[74:75], v[74:75], v[20:21]
  v_pk_mul_f32 v[76:77], v[76:77], v[20:21]
  v_pk_mul_f32 v[78:79], v[78:79], v[20:21]
  v_pk_mul_f32 v[80:81], v[80:81], v[20:21]
  v_pk_mul_f32 v[82:83], v[82:83], v[20:21]
  v_pk_mul_f32 v[84:85], v[84:85], v[20:21]
  v_pk_mul_f32 v[86:87], v[86:87], v[20:21]
  v_pk_mul_f32 v[88:89], v[88:89], v[20:21]
  v_pk_mul_f32 v[90:91], v[90:91], v[20:21]
  v_pk_mul_f32 v[92:93], v[92:93], v[20:21]
  v_pk_mul_f32 v[94:95], v[94:95], v[20:21]
  v_cvt_pk_bf16_f32 v96, v64, v65
  v_cvt_pk_bf16_f32 v97, v66, v67
  v_cvt_pk_bf16_f32 v98, v68, v69
  v_cvt_pk_bf16_f32 v99, v70, v71
  v_cvt_pk_bf16_f32 v100, v72, v73
  v_cvt_pk_bf16_f32 v101, v74, v75
  v_cvt_pk_bf16_f32 v102, v76, v77
  v_cvt_pk_bf16_f32 v103, v78, v79
  v_cvt_pk_bf16_f32 v104, v80, v81
  v_cvt_pk_bf16_f32 v105, v82, v83
  v_cvt_pk_bf16_f32 v106, v84, v85
  v_cvt_pk_bf16_f32 v107, v86, v87
  v_cvt_pk_bf16_f32 v108, v88, v89
  v_cvt_pk_bf16_f32 v109, v90, v91
  v_cvt_pk_bf16_f32 v110, v92, v93
  v_cvt_pk_bf16_f32 v111, v94, v95
  v_accvgpr_write_b32 a32, v96
  v_accvgpr_write_b32 a33, v97
  v_accvgpr_write_b32 a34, v98
  v_accvgpr_write_b32 a35, v99
  v_accvgpr_write_b32 a36, v100
  v_accvgpr_write_b32 a37, v101
  v_accvgpr_write_b32 a38, v102
  v_accvgpr_write_b32 a39, v103
  v_accvgpr_write_b32 a40, v104
  v_accvgpr_write_b32 a41, v105
  v_accvgpr_write_b32 a42, v106
  v_accvgpr_write_b32 a43, v107
  v_accvgpr_write_b32 a44, v108
  v_accvgpr_write_b32 a45, v109
  v_accvgpr_write_b32 a46, v110
  v_accvgpr_write_b32 a47, v111
  v_accvgpr_read_b32 v64, a96
  v_accvgpr_read_b32 v65, a97
  v_accvgpr_read_b32 v66, a98
  v_accvgpr_read_b32 v67, a99
  v_accvgpr_read_b32 v68, a112
  v_accvgpr_read_b32 v69, a113
  v_accvgpr_read_b32 v70, a114
  v_accvgpr_read_b32 v71, a115
  v_accvgpr_read_b32 v72, a100
  v_accvgpr_read_b32 v73, a101
  v_accvgpr_read_b32 v74, a102
  v_accvgpr_read_b32 v75, a103
  v_accvgpr_read_b32 v76, a116
  v_accvgpr_read_b32 v77, a117
  v_accvgpr_read_b32 v78, a118
  v_accvgpr_read_b32 v79, a119
  v_accvgpr_read_b32 v80, a104
  v_accvgpr_read_b32 v81, a105
  v_accvgpr_read_b32 v82, a106
  v_accvgpr_read_b32 v83, a107
  v_accvgpr_read_b32 v84, a120
  v_accvgpr_read_b32 v85, a121
  v_accvgpr_read_b32 v86, a122
  v_accvgpr_read_b32 v87, a123
  v_accvgpr_read_b32 v88, a108
  v_accvgpr_read_b32 v89, a109
  v_accvgpr_read_b32 v90, a110
  v_accvgpr_read_b32 v91, a111
  v_accvgpr_read_b32 v92, a124
  v_accvgpr_read_b32 v93, a125
  v_accvgpr_read_b32 v94, a126
  v_accvgpr_read_b32 v95, a127
  v_pk_mul_f32 v[64:65], v[64:65], v[20:21]
  v_pk_mul_f32 v[66:67], v[66:67], v[20:21]
  v_pk_mul_f32 v[68:69], v[68:69], v[20:21]
  v_pk_mul_f32 v[70:71], v[70:71], v[20:21]
  v_pk_mul_f32 v[72:73], v[72:73], v[20:21]
  v_pk_mul_f32 v[74:75], v[74:75], v[20:21]
  v_pk_mul_f32 v[76:77], v[76:77], v[20:21]
  v_pk_mul_f32 v[78:79], v[78:79], v[20:21]
  v_pk_mul_f32 v[80:81], v[80:81], v[20:21]
  v_pk_mul_f32 v[82:83], v[82:83], v[20:21]
  v_pk_mul_f32 v[84:85], v[84:85], v[20:21]
  v_pk_mul_f32 v[86:87], v[86:87], v[20:21]
  v_pk_mul_f32 v[88:89], v[88:89], v[20:21]
  v_pk_mul_f32 v[90:91], v[90:91], v[20:21]
  v_pk_mul_f32 v[92:93], v[92:93], v[20:21]
  v_pk_mul_f32 v[94:95], v[94:95], v[20:21]
  v_cvt_pk_bf16_f32 v96, v64, v65
  v_cvt_pk_bf16_f32 v97, v66, v67
  v_cvt_pk_bf16_f32 v98, v68, v69
  v_cvt_pk_bf16_f32 v99, v70, v71
  v_cvt_pk_bf16_f32 v100, v72, v73
  v_cvt_pk_bf16_f32 v101, v74, v75
  v_cvt_pk_bf16_f32 v102, v76, v77
  v_cvt_pk_bf16_f32 v103, v78, v79
  v_cvt_pk_bf16_f32 v104, v80, v81
  v_cvt_pk_bf16_f32 v105, v82, v83
  v_cvt_pk_bf16_f32 v106, v84, v85
  v_cvt_pk_bf16_f32 v107, v86, v87
  v_cvt_pk_bf16_f32 v108, v88, v89
  v_cvt_pk_bf16_f32 v109, v90, v91
  v_cvt_pk_bf16_f32 v110, v92, v93
  v_cvt_pk_bf16_f32 v111, v94, v95
  v_accvgpr_write_b32 a48, v96
  v_accvgpr_write_b32 a49, v97
  v_accvgpr_write_b32 a50, v98
  v_accvgpr_write_b32 a51, v99
  v_accvgpr_write_b32 a52, v100
  v_accvgpr_write_b32 a53, v101
  v_accvgpr_write_b32 a54, v102
  v_accvgpr_write_b32 a55, v103
  v_accvgpr_write_b32 a56, v104
  v_accvgpr_write_b32 a57, v105
  v_accvgpr_write_b32 a58, v106
  v_accvgpr_write_b32 a59, v107
  v_accvgpr_write_b32 a60, v108
  v_accvgpr_write_b32 a61, v109
  v_accvgpr_write_b32 a62, v110
  v_accvgpr_write_b32 a63, v111
  v_pk_mul_f32 v[128:129], v[128:129], v[20:21]
  v_pk_mul_f32 v[130:131], v[130:131], v[20:21]
  v_pk_mul_f32 v[144:145], v[144:145], v[20:21]
  v_pk_mul_f32 v[146:147], v[146:147], v[20:21]
  v_pk_mul_f32 v[132:133], v[132:133], v[20:21]
  v_pk_mul_f32 v[134:135], v[134:135], v[20:21]
  v_pk_mul_f32 v[148:149], v[148:149], v[20:21]
  v_pk_mul_f32 v[150:151], v[150:151], v[20:21]
  v_pk_mul_f32 v[136:137], v[136:137], v[20:21]
  v_pk_mul_f32 v[138:139], v[138:139], v[20:21]
  v_pk_mul_f32 v[152:153], v[152:153], v[20:21]
  v_pk_mul_f32 v[154:155], v[154:155], v[20:21]
  v_pk_mul_f32 v[140:141], v[140:141], v[20:21]
  v_pk_mul_f32 v[142:143], v[142:143], v[20:21]
  v_pk_mul_f32 v[156:157], v[156:157], v[20:21]
  v_pk_mul_f32 v[158:159], v[158:159], v[20:21]
  v_cvt_pk_bf16_f32 v128, v128, v129
  v_cvt_pk_bf16_f32 v129, v130, v131
  v_cvt_pk_bf16_f32 v130, v144, v145
  v_cvt_pk_bf16_f32 v131, v146, v147
  v_cvt_pk_bf16_f32 v132, v132, v133
  v_cvt_pk_bf16_f32 v133, v134, v135
  v_cvt_pk_bf16_f32 v134, v148, v149
  v_cvt_pk_bf16_f32 v135, v150, v151
  v_cvt_pk_bf16_f32 v136, v136, v137
  v_cvt_pk_bf16_f32 v137, v138, v139
  v_cvt_pk_bf16_f32 v138, v152, v153
  v_cvt_pk_bf16_f32 v139, v154, v155
  v_cvt_pk_bf16_f32 v140, v140, v141
  v_cvt_pk_bf16_f32 v141, v142, v143
  v_cvt_pk_bf16_f32 v142, v156, v157
  v_cvt_pk_bf16_f32 v143, v158, v159
  v_accvgpr_write_b32 a64, v128
  v_accvgpr_write_b32 a65, v129
  v_accvgpr_write_b32 a66, v130
  v_accvgpr_write_b32 a67, v131
  v_accvgpr_write_b32 a68, v132
  v_accvgpr_write_b32 a69, v133
  v_accvgpr_write_b32 a70, v134
  v_accvgpr_write_b32 a71, v135
  v_accvgpr_write_b32 a72, v136
  v_accvgpr_write_b32 a73, v137
  v_accvgpr_write_b32 a74, v138
  v_accvgpr_write_b32 a75, v139
  v_accvgpr_write_b32 a76, v140
  v_accvgpr_write_b32 a77, v141
  v_accvgpr_write_b32 a78, v142
  v_accvgpr_write_b32 a79, v143
  v_pk_mul_f32 v[160:161], v[160:161], v[20:21]
  v_pk_mul_f32 v[162:163], v[162:163], v[20:21]
  v_pk_mul_f32 v[176:177], v[176:177], v[20:21]
  v_pk_mul_f32 v[178:179], v[178:179], v[20:21]
  v_pk_mul_f32 v[164:165], v[164:165], v[20:21]
  v_pk_mul_f32 v[166:167], v[166:167], v[20:21]
  v_pk_mul_f32 v[180:181], v[180:181], v[20:21]
  v_pk_mul_f32 v[182:183], v[182:183], v[20:21]
  v_pk_mul_f32 v[168:169], v[168:169], v[20:21]
  v_pk_mul_f32 v[170:171], v[170:171], v[20:21]
  v_pk_mul_f32 v[184:185], v[184:185], v[20:21]
  v_pk_mul_f32 v[186:187], v[186:187], v[20:21]
  v_pk_mul_f32 v[172:173], v[172:173], v[20:21]
  v_pk_mul_f32 v[174:175], v[174:175], v[20:21]
  v_pk_mul_f32 v[188:189], v[188:189], v[20:21]
  v_pk_mul_f32 v[190:191], v[190:191], v[20:21]
  v_cvt_pk_bf16_f32 v160, v160, v161
  v_cvt_pk_bf16_f32 v161, v162, v163
  v_cvt_pk_bf16_f32 v162, v176, v177
  v_cvt_pk_bf16_f32 v163, v178, v179
  v_cvt_pk_bf16_f32 v164, v164, v165
  v_cvt_pk_bf16_f32 v165, v166, v167
  v_cvt_pk_bf16_f32 v166, v180, v181
  v_cvt_pk_bf16_f32 v167, v182, v183
  v_cvt_pk_bf16_f32 v168, v168, v169
  v_cvt_pk_bf16_f32 v169, v170, v171
  v_cvt_pk_bf16_f32 v170, v184, v185
  v_cvt_pk_bf16_f32 v171, v186, v187
  v_cvt_pk_bf16_f32 v172, v172, v173
  v_cvt_pk_bf16_f32 v173, v174, v175
  v_cvt_pk_bf16_f32 v174, v188, v189
  v_cvt_pk_bf16_f32 v175, v190, v191
  v_accvgpr_write_b32 a80, v160
  v_accvgpr_write_b32 a81, v161
  v_accvgpr_write_b32 a82, v162
  v_accvgpr_write_b32 a83, v163
  v_accvgpr_write_b32 a84, v164
  v_accvgpr_write_b32 a85, v165
  v_accvgpr_write_b32 a86, v166
  v_accvgpr_write_b32 a87, v167
  v_accvgpr_write_b32 a88, v168
  v_accvgpr_write_b32 a89, v169
  v_accvgpr_write_b32 a90, v170
  v_accvgpr_write_b32 a91, v171
  v_accvgpr_write_b32 a92, v172
  v_accvgpr_write_b32 a93, v173
  v_accvgpr_write_b32 a94, v174
  v_accvgpr_write_b32 a95, v175
  v_pk_mul_f32 v[192:193], v[192:193], v[20:21]
  v_pk_mul_f32 v[194:195], v[194:195], v[20:21]
  v_pk_mul_f32 v[208:209], v[208:209], v[20:21]
  v_pk_mul_f32 v[210:211], v[210:211], v[20:21]
  v_pk_mul_f32 v[196:197], v[196:197], v[20:21]
  v_pk_mul_f32 v[198:199], v[198:199], v[20:21]
  v_pk_mul_f32 v[212:213], v[212:213], v[20:21]
  v_pk_mul_f32 v[214:215], v[214:215], v[20:21]
  v_pk_mul_f32 v[200:201], v[200:201], v[20:21]
  v_pk_mul_f32 v[202:203], v[202:203], v[20:21]
  v_pk_mul_f32 v[216:217], v[216:217], v[20:21]
  v_pk_mul_f32 v[218:219], v[218:219], v[20:21]
  v_pk_mul_f32 v[204:205], v[204:205], v[20:21]
  v_pk_mul_f32 v[206:207], v[206:207], v[20:21]
  v_pk_mul_f32 v[220:221], v[220:221], v[20:21]
  v_pk_mul_f32 v[222:223], v[222:223], v[20:21]
  v_cvt_pk_bf16_f32 v192, v192, v193
  v_cvt_pk_bf16_f32 v193, v194, v195
  v_cvt_pk_bf16_f32 v194, v208, v209
  v_cvt_pk_bf16_f32 v195, v210, v211
  v_cvt_pk_bf16_f32 v196, v196, v197
  v_cvt_pk_bf16_f32 v197, v198, v199
  v_cvt_pk_bf16_f32 v198, v212, v213
  v_cvt_pk_bf16_f32 v199, v214, v215
  v_cvt_pk_bf16_f32 v200, v200, v201
  v_cvt_pk_bf16_f32 v201, v202, v203
  v_cvt_pk_bf16_f32 v202, v216, v217
  v_cvt_pk_bf16_f32 v203, v218, v219
  v_cvt_pk_bf16_f32 v204, v204, v205
  v_cvt_pk_bf16_f32 v205, v206, v207
  v_cvt_pk_bf16_f32 v206, v220, v221
  v_cvt_pk_bf16_f32 v207, v222, v223
  v_accvgpr_write_b32 a96, v192
  v_accvgpr_write_b32 a97, v193
  v_accvgpr_write_b32 a98, v194
  v_accvgpr_write_b32 a99, v195
  v_accvgpr_write_b32 a100, v196
  v_accvgpr_write_b32 a101, v197
  v_accvgpr_write_b32 a102, v198
  v_accvgpr_write_b32 a103, v199
  v_accvgpr_write_b32 a104, v200
  v_accvgpr_write_b32 a105, v201
  v_accvgpr_write_b32 a106, v202
  v_accvgpr_write_b32 a107, v203
  v_accvgpr_write_b32 a108, v204
  v_accvgpr_write_b32 a109, v205
  v_accvgpr_write_b32 a110, v206
  v_accvgpr_write_b32 a111, v207
  v_pk_mul_f32 v[224:225], v[224:225], v[20:21]
  v_pk_mul_f32 v[226:227], v[226:227], v[20:21]
  v_pk_mul_f32 v[240:241], v[240:241], v[20:21]
  v_pk_mul_f32 v[242:243], v[242:243], v[20:21]
  v_pk_mul_f32 v[228:229], v[228:229], v[20:21]
  v_pk_mul_f32 v[230:231], v[230:231], v[20:21]
  v_pk_mul_f32 v[244:245], v[244:245], v[20:21]
  v_pk_mul_f32 v[246:247], v[246:247], v[20:21]
  v_pk_mul_f32 v[232:233], v[232:233], v[20:21]
  v_pk_mul_f32 v[234:235], v[234:235], v[20:21]
  v_pk_mul_f32 v[248:249], v[248:249], v[20:21]
  v_pk_mul_f32 v[250:251], v[250:251], v[20:21]
  v_pk_mul_f32 v[236:237], v[236:237], v[20:21]
  v_pk_mul_f32 v[238:239], v[238:239], v[20:21]
  v_pk_mul_f32 v[252:253], v[252:253], v[20:21]
  v_pk_mul_f32 v[254:255], v[254:255], v[20:21]
  v_cvt_pk_bf16_f32 v224, v224, v225
  v_cvt_pk_bf16_f32 v225, v226, v227
  v_cvt_pk_bf16_f32 v226, v240, v241
  v_cvt_pk_bf16_f32 v227, v242, v243
  v_cvt_pk_bf16_f32 v228, v228, v229
  v_cvt_pk_bf16_f32 v229, v230, v231
  v_cvt_pk_bf16_f32 v230, v244, v245
  v_cvt_pk_bf16_f32 v231, v246, v247
  v_cvt_pk_bf16_f32 v232, v232, v233
  v_cvt_pk_bf16_f32 v233, v234, v235
  v_cvt_pk_bf16_f32 v234, v248, v249
  v_cvt_pk_bf16_f32 v235, v250, v251
  v_cvt_pk_bf16_f32 v236, v236, v237
  v_cvt_pk_bf16_f32 v237, v238, v239
  v_cvt_pk_bf16_f32 v238, v252, v253
  v_cvt_pk_bf16_f32 v239, v254, v255
  v_accvgpr_write_b32 a112, v224
  v_accvgpr_write_b32 a113, v225
  v_accvgpr_write_b32 a114, v226
  v_accvgpr_write_b32 a115, v227
  v_accvgpr_write_b32 a116, v228
  v_accvgpr_write_b32 a117, v229
  v_accvgpr_write_b32 a118, v230
  v_accvgpr_write_b32 a119, v231
  v_accvgpr_write_b32 a120, v232
  v_accvgpr_write_b32 a121, v233
  v_accvgpr_write_b32 a122, v234
  v_accvgpr_write_b32 a123, v235
  v_accvgpr_write_b32 a124, v236
  v_accvgpr_write_b32 a125, v237
  v_accvgpr_write_b32 a126, v238
  v_accvgpr_write_b32 a127, v239
  s_cmp_lg_u32 s69, 0
  s_cbranch_scc1 L_slow
  s_waitcnt vmcnt(16)
  s_barrier
  ds_read_b128 a[128:131], v2 offset:16384
  ds_read_b128 a[132:135], v3 offset:16384
  ds_read_b128 a[136:139], v4 offset:16384
  ds_read_b128 a[140:143], v5 offset:16384
  ds_read_b128 a[144:147], v2 offset:20480
  ds_read_b128 a[148:151], v3 offset:20480
  ds_read_b128 a[152:155], v4 offset:20480
  ds_read_b128 a[156:159], v5 offset:20480
  s_waitcnt lgkmcnt(0)
  v_mfma_f32_16x16x32_bf16 v[64:67], a[128:131], a[0:3], 0
  v_mfma_f32_16x16x32_bf16 v[64:67], a[132:135], a[16:19], v[64:67]
  v_mfma_f32_16x16x32_bf16 v[64:67], a[136:139], a[32:35], v[64:67]
  v_mfma_f32_16x16x32_bf16 v[64:67], a[140:143], a[48:51], v[64:67]
  v_mfma_f32_16x16x32_bf16 v[68:71], a[144:147], a[0:3], 0
  v_mfma_f32_16x16x32_bf16 v[68:71], a[148:151], a[16:19], v[68:71]
  v_mfma_f32_16x16x32_bf16 v[68:71], a[152:155], a[32:35], v[68:71]
  v_mfma_f32_16x16x32_bf16 v[68:71], a[156:159], a[48:51], v[68:71]
  v_mfma_f32_16x16x32_bf16 v[72:75], a[128:131], a[4:7], 0
  v_mfma_f32_16x16x32_bf16 v[72:75], a[132:135], a[20:23], v[72:75]
  v_mfma_f32_16x16x32_bf16 v[72:75], a[136:139], a[36:39], v[72:75]
  v_mfma_f32_16x16x32_bf16 v[72:75], a[140:143], a[52:55], v[72:75]
  v_max3_f32 v22, v64, v65, v66
  s_nop 2
  v_max3_f32 v22, v22, v67, v68
  v_mfma_f32_16x16x32_bf16 v[76:79], a[144:147], a[4:7], 0
  v_max3_f32 v22, v22, v69, v70
  v_max_f32 v22, v22, v71
  v_mfma_f32_16x16x32_bf16 v[76:79], a[148:151], a[20:23], v[76:79]
  v_mov_b32 v23, v22
  s_nop 1
  v_permlane16_swap_b32 v22, v23
  v_mfma_f32_16x16x32_bf16 v[76:79], a[152:155], a[36:39], v[76:79]
  v_max_f32 v22, v22, v23
  v_mov_b32 v23, v22
  v_mfma_f32_16x16x32_bf16 v[76:79], a[156:159], a[52:55], v[76:79]
  s_nop 0
  v_permlane32_swap_b32 v22, v23
  v_max_f32 v22, v22, v23
  v_mfma_f32_16x16x32_bf16 v[80:83], a[128:131], a[8:11], 0
  v_sub_f32 v32, 0, v22
  v_sub_f32 v33, 0, v22
  v_mfma_f32_16x16x32_bf16 v[80:83], a[132:135], a[24:27], v[80:83]
  v_sub_f32 v34, 0, v22
  v_sub_f32 v35, 0, v22
  v_mfma_f32_16x16x32_bf16 v[80:83], a[136:139], a[40:43], v[80:83]
  v_sub_f32 v64, v64, v22
  v_sub_f32 v65, v65, v22
  v_mfma_f32_16x16x32_bf16 v[80:83], a[140:143], a[56:59], v[80:83]
  v_sub_f32 v66, v66, v22
  v_sub_f32 v67, v67, v22
  v_mfma_f32_16x16x32_bf16 v[84:87], a[144:147], a[8:11], 0
  v_sub_f32 v68, v68, v22
  v_sub_f32 v69, v69, v22
  v_mfma_f32_16x16x32_bf16 v[84:87], a[148:151], a[24:27], v[84:87]
  v_sub_f32 v70, v70, v22
  v_sub_f32 v71, v71, v22
  v_mfma_f32_16x16x32_bf16 v[84:87], a[152:155], a[40:43], v[84:87]
  v_exp_f32 v64, v64
  v_mfma_f32_16x16x32_bf16 v[84:87], a[156:159], a[56:59], v[84:87]
  v_exp_f32 v65, v65
  v_mfma_f32_16x16x32_bf16 v[88:91], a[128:131], a[12:15], 0
  v_exp_f32 v66, v66
  v_mfma_f32_16x16x32_bf16 v[88:91], a[132:135], a[28:31], v[88:91]
  v_exp_f32 v67, v67
  v_mfma_f32_16x16x32_bf16 v[88:91], a[136:139], a[44:47], v[88:91]
  v_exp_f32 v68, v68
  v_mfma_f32_16x16x32_bf16 v[88:91], a[140:143], a[60:63], v[88:91]
  v_exp_f32 v69, v69
  v_mfma_f32_16x16x32_bf16 v[92:95], a[144:147], a[12:15], 0
  v_exp_f32 v70, v70
  v_mfma_f32_16x16x32_bf16 v[92:95], a[148:151], a[28:31], v[92:95]
  v_exp_f32 v71, v71
  v_mfma_f32_16x16x32_bf16 v[92:95], a[152:155], a[44:47], v[92:95]
  v_cvt_pk_bf16_f32 v96, v64, v65
  v_cvt_pk_bf16_f32 v97, v66, v67
  v_mfma_f32_16x16x32_bf16 v[92:95], a[156:159], a[60:63], v[92:95]
  v_cvt_pk_bf16_f32 v98, v68, v69
  v_cvt_pk_bf16_f32 v99, v70, v71
  ds_read_b128 a[128:131], v2 offset:24576
  v_max3_f32 v24, v72, v73, v74
  ds_read_b128 a[132:135], v3 offset:24576
  v_max3_f32 v24, v24, v75, v76
  ds_read_b128 a[136:139], v4 offset:24576
  v_max3_f32 v24, v24, v77, v78
  ds_read_b128 a[140:143], v5 offset:24576
  v_max_f32 v24, v24, v79
  ds_read_b128 a[144:147], v2 offset:28672
  v_mov_b32 v25, v24
  ds_read_b128 a[148:151], v3 offset:28672
  s_nop 0
  v_permlane16_swap_b32 v24, v25
  ds_read_b128 a[152:155], v4 offset:28672
  v_max_f32 v24, v24, v25
  ds_read_b128 a[156:159], v5 offset:28672
  v_mov_b32 v25, v24
  s_nop 1
  v_permlane32_swap_b32 v24, v25
  v_max_f32 v24, v24, v25
  v_sub_f32 v36, 0, v24
  v_sub_f32 v37, 0, v24
  v_sub_f32 v38, 0, v24
  v_sub_f32 v39, 0, v24
  v_sub_f32 v72, v72, v24
  v_sub_f32 v73, v73, v24
  v_sub_f32 v74, v74, v24
  v_sub_f32 v75, v75, v24
  v_sub_f32 v76, v76, v24
  v_sub_f32 v77, v77, v24
  v_sub_f32 v78, v78, v24
  v_sub_f32 v79, v79, v24
  v_exp_f32 v72, v72
  v_exp_f32 v73, v73
  v_exp_f32 v74, v74
  v_exp_f32 v75, v75
  v_exp_f32 v76, v76
  v_xor_b32 v2, 0x8000, v2
  v_xor_b32 v3, 0x8000, v3
  s_waitcnt vmcnt(0) lgkmcnt(0)
  ds_add_u32 v30, a255
  v_xor_b32 v4, 0x8000, v4
  v_xor_b32 v5, 0x8000, v5
  v_exp_f32 v77, v77
  v_exp_f32 v78, v78
  v_exp_f32 v79, v79
  v_cvt_pk_bf16_f32 v100, v72, v73
  v_cvt_pk_bf16_f32 v101, v74, v75
  v_cvt_pk_bf16_f32 v102, v76, v77
  v_cvt_pk_bf16_f32 v103, v78, v79
  v_max3_f32 v22, v80, v81, v82
  v_max3_f32 v22, v22, v83, v84
  ds_read_b32 v0, v30
  v_max3_f32 v22, v22, v85, v86
  v_max_f32 v22, v22, v87
  v_mov_b32 v23, v22
  s_nop 0
  s_nop 0
  v_permlane16_swap_b32 v22, v23
  v_max_f32 v22, v22, v23
  v_mov_b32 v23, v22
  s_nop 0
  s_nop 0
  v_permlane32_swap_b32 v22, v23
  v_max_f32 v22, v22, v23
  v_sub_f32 v40, 0, v22
  v_sub_f32 v41, 0, v22
  v_sub_f32 v42, 0, v22
  s_waitcnt lgkmcnt(0)
  v_cmp_gt_u32 vcc, s68, v0
  v_sub_f32 v43, 0, v22
  v_sub_f32 v80, v80, v22
  v_sub_f32 v81, v81, v22
  v_sub_f32 v82, v82, v22
  v_sub_f32 v83, v83, v22
  v_sub_f32 v84, v84, v22
  v_sub_f32 v85, v85, v22
  v_sub_f32 v86, v86, v22
  v_sub_f32 v87, v87, v22
  v_exp_f32 v80, v80
  v_exp_f32 v81, v81
  v_exp_f32 v82, v82
  v_exp_f32 v83, v83
  v_exp_f32 v84, v84
  v_exp_f32 v85, v85
  v_exp_f32 v86, v86
  v_exp_f32 v87, v87
  v_cvt_pk_bf16_f32 v104, v80, v81
  v_cvt_pk_bf16_f32 v105, v82, v83
  v_cvt_pk_bf16_f32 v106, v84, v85
  v_cvt_pk_bf16_f32 v107, v86, v87
  v_max3_f32 v24, v88, v89, v90
  v_max3_f32 v24, v24, v91, v92
  v_max3_f32 v24, v24, v93, v94
  v_max_f32 v24, v24, v95
  v_mov_b32 v25, v24
  s_nop 0
  s_nop 0
  v_permlane16_swap_b32 v24, v25
  v_max_f32 v24, v24, v25
  v_mov_b32 v25, v24
  s_nop 0
  s_nop 0
  v_permlane32_swap_b32 v24, v25
  v_max_f32 v24, v24, v25
  v_sub_f32 v44, 0, v24
  v_sub_f32 v45, 0, v24
  v_sub_f32 v46, 0, v24
  v_sub_f32 v47, 0, v24
  v_sub_f32 v88, v88, v24
  v_sub_f32 v89, v89, v24
  v_sub_f32 v90, v90, v24
  v_sub_f32 v91, v91, v24
  v_sub_f32 v92, v92, v24
  v_sub_f32 v93, v93, v24
  v_sub_f32 v94, v94, v24
  v_sub_f32 v95, v95, v24
  v_exp_f32 v88, v88
  v_exp_f32 v89, v89
  v_exp_f32 v90, v90
  v_exp_f32 v91, v91
  v_exp_f32 v92, v92
  v_exp_f32 v93, v93
  v_exp_f32 v94, v94
  v_exp_f32 v95, v95
  v_cvt_pk_bf16_f32 v108, v88, v89
  v_cvt_pk_bf16_f32 v109, v90, v91
  v_cvt_pk_bf16_f32 v110, v92, v93
  v_cvt_pk_bf16_f32 v111, v94, v95
  s_cbranch_vccnz L_spin6
L_spin6_ret:
  s_add_u32 s68, s68, 4
  s_waitcnt lgkmcnt(0)
  s_mov_b32 s30, 0
  v_mov_b32 v84, 0
  v_mov_b32 v85, 0
  v_mov_b32 v86, 0
  v_mov_b32 v87, 0
  s_nop 1
  v_mfma_f32_32x32x16_bf16 v[128:143], v[84:87], v[84:87], 0
  v_mfma_f32_32x32x16_bf16 v[144:159], v[84:87], v[84:87], 0
  v_mfma_f32_32x32x16_bf16 v[160:175], v[84:87], v[84:87], 0
  v_mfma_f32_32x32x16_bf16 v[176:191], v[84:87], v[84:87], 0
  v_mfma_f32_32x32x16_bf16 v[192:207], v[84:87], v[84:87], 0
  v_mfma_f32_32x32x16_bf16 v[208:223], v[84:87], v[84:87], 0
  v_mfma_f32_32x32x16_bf16 v[224:239], v[84:87], v[84:87], 0
  v_mfma_f32_32x32x16_bf16 v[240:255], v[84:87], v[84:87], 0
  v_mfma_f32_32x32x16_bf16 v[48:63], v[84:87], v[84:87], 0
L_aloop:
  v_mfma_f32_16x16x32_bf16 v[64:67], a[128:131], a[0:3], v[32:35]
  s_mov_b32 m0, s29
  ds_read_b64_tr_b16 a[160:161], v6 offset:0
  v_mfma_f32_16x16x32_bf16 v[64:67], a[132:135], a[16:19], v[64:67]
  ds_read_b64_tr_b16 a[162:163], v6 offset:4096
  buffer_load_dwordx4 v14, s[4:7], s26 offen offset:0 nt lds
  v_mfma_f32_16x16x32_bf16 v[64:67], a[136:139], a[32:35], v[64:67]
  ds_read_b64_tr_b16 a[164:165], v7 offset:0
  v_mfma_f32_16x16x32_bf16 v[64:67], a[140:143], a[48:51], v[64:67]
  ds_read_b64_tr_b16 a[166:167], v7 offset:4096
  buffer_load_dwordx4 v15, s[4:7], s26 offen offset:1024 nt lds
  v_mfma_f32_16x16x32_bf16 v[68:71], a[144:147], a[0:3], v[32:35]
  ds_read_b64_tr_b16 a[168:169], v8 offset:0
  v_mfma_f32_16x16x32_bf16 v[68:71], a[148:151], a[16:19], v[68:71]
  ds_read_b64_tr_b16 a[170:171], v8 offset:4096
  buffer_load_dwordx4 v16, s[4:7], s26 offen offset:2048 nt lds
  v_mfma_f32_16x16x32_bf16 v[68:71], a[152:155], a[32:35], v[68:71]
  ds_read_b64_tr_b16 a[172:173], v9 offset:0
  v_mfma_f32_16x16x32_bf16 v[68:71], a[156:159], a[48:51], v[68:71]
  ds_read_b64_tr_b16 a[174:175], v9 offset:4096
  buffer_load_dwordx4 v17, s[4:7], s26 offen offset:3072 nt lds
  v_mfma_f32_16x16x32_bf16 v[72:75], a[128:131], a[4:7], v[36:39]
  s_add_u32 s29, s29, 0x4000
  s_and_b32 s29, s29, 0xffff
  v_exp_f32 v64, v64
  v_mfma_f32_16x16x32_bf16 v[72:75], a[132:135], a[20:23], v[72:75]
  s_add_u32 s26, s26, 0x4000
  ds_read_b64_tr_b16 a[176:177], v10 offset:0
  v_mfma_f32_16x16x32_bf16 v[72:75], a[136:139], a[36:39], v[72:75]
  v_exp_f32 v65, v65
  v_mfma_f32_16x16x32_bf16 v[72:75], a[140:143], a[52:55], v[72:75]
  ds_read_b64_tr_b16 a[178:179], v10 offset:4096
  v_cvt_pk_bf16_f32 v112, v64, v65
  v_mfma_f32_16x16x32_bf16 v[76:79], a[144:147], a[4:7], v[36:39]
  v_exp_f32 v66, v66
  v_mfma_f32_16x16x32_bf16 v[76:79], a[148:151], a[20:23], v[76:79]
  ds_read_b64_tr_b16 a[180:181], v11 offset:0
  v_mfma_f32_16x16x32_bf16 v[76:79], a[152:155], a[36:39], v[76:79]
  v_exp_f32 v67, v67
  v_mfma_f32_16x16x32_bf16 v[76:79], a[156:159], a[52:55], v[76:79]
  v_exp_f32 v68, v68
  v_mfma_f32_16x16x32_bf16 v[80:83], a[128:131], a[8:11], v[40:43]
  ds_read_b64_tr_b16 a[182:183], v11 offset:4096
  v_cvt_pk_bf16_f32 v113, v66, v67
  v_mfma_f32_16x16x32_bf16 v[80:83], a[132:135], a[24:27], v[80:83]
  v_exp_f32 v69, v69
  v_mfma_f32_16x16x32_bf16 v[80:83], a[136:139], a[40:43], v[80:83]
  ds_read_b64_tr_b16 a[184:185], v12 offset:0
  v_cvt_pk_bf16_f32 v114, v68, v69
  v_mfma_f32_16x16x32_bf16 v[80:83], a[140:143], a[56:59], v[80:83]
  v_exp_f32 v70, v70
  v_mfma_f32_16x16x32_bf16 v[84:87], a[144:147], a[8:11], v[40:43]
  ds_read_b64_tr_b16 a[186:187], v12 offset:4096
  v_mfma_f32_16x16x32_bf16 v[84:87], a[148:151], a[24:27], v[84:87]
  v_exp_f32 v71, v71
  v_mfma_f32_16x16x32_bf16 v[84:87], a[152:155], a[40:43], v[84:87]
  ds_read_b64_tr_b16 a[188:189], v13 offset:0
  v_cvt_pk_bf16_f32 v115, v70, v71
  v_mfma_f32_16x16x32_bf16 v[84:87], a[156:159], a[56:59], v[84:87]
  v_exp_f32 v72, v72
  v_mfma_f32_16x16x32_bf16 v[88:91], a[128:131], a[12:15], v[44:47]
  ds_read_b64_tr_b16 a[190:191], v13 offset:4096
  v_mfma_f32_16x16x32_bf16 v[88:91], a[132:135], a[28:31], v[88:91]
  v_exp_f32 v73, v73
  v_mfma_f32_16x16x32_bf16 v[88:91], a[136:139], a[44:47], v[88:91]
  v_exp_f32 v74, v74
  v_mfma_f32_16x16x32_bf16 v[88:91], a[140:143], a[60:63], v[88:91]
  v_cvt_pk_bf16_f32 v116, v72, v73
  v_mfma_f32_16x16x32_bf16 v[92:95], a[144:147], a[12:15], v[44:47]
  v_exp_f32 v75, v75
  v_mfma_f32_16x16x32_bf16 v[92:95], a[148:151], a[28:31], v[92:95]
  v_cvt_pk_bf16_f32 v117, v74, v75
  v_mfma_f32_16x16x32_bf16 v[92:95], a[152:155], a[44:47], v[92:95]
  v_exp_f32 v76, v76
  v_mfma_f32_16x16x32_bf16 v[92:95], a[156:159], a[60:63], v[92:95]
  s_waitcnt lgkmcnt(0)
  v_mfma_f32_16x16x32_bf16 v[128:131], a[160:163], v[96:99], v[128:131]
  v_exp_f32 v77, v77
  v_mfma_f32_16x16x32_bf16 v[144:147], a[164:167], v[96:99], v[144:147]
  ds_read_b128 a[128:131], v2 offset:0
  v_cvt_pk_bf16_f32 v118, v76, v77
  v_mfma_f32_16x16x32_bf16 v[160:163], a[168:171], v[96:99], v[160:163]
  v_exp_f32 v78, v78
  v_mfma_f32_16x16x32_bf16 v[176:179], a[172:175], v[96:99], v[176:179]
  ds_read_b128 a[132:135], v3 offset:0
  v_mfma_f32_16x16x32_bf16 v[192:195], a[176:179], v[96:99], v[192:195]
  v_exp_f32 v79, v79
  v_mfma_f32_16x16x32_bf16 v[208:211], a[180:183], v[96:99], v[208:211]
  v_exp_f32 v80, v80
  v_mfma_f32_16x16x32_bf16 v[224:227], a[184:187], v[96:99], v[224:227]
  ds_read_b128 a[136:139], v4 offset:0
  v_cvt_pk_bf16_f32 v119, v78, v79
  v_mfma_f32_16x16x32_bf16 v[240:243], a[188:191], v[96:99], v[240:243]
  v_exp_f32 v81, v81
  v_mfma_f32_16x16x32_bf16 v[48:51], a[192:195], v[96:99], v[48:51]
  ds_read_b128 a[140:143], v5 offset:0
  v_cvt_pk_bf16_f32 v120, v80, v81
  v_mfma_f32_16x16x32_bf16 v[132:135], a[160:163], v[100:103], v[132:135]
  v_exp_f32 v82, v82
  v_mfma_f32_16x16x32_bf16 v[148:151], a[164:167], v[100:103], v[148:151]
  ds_read_b128 a[144:147], v2 offset:4096
  v_mfma_f32_16x16x32_bf16 v[164:167], a[168:171], v[100:103], v[164:167]
  v_exp_f32 v83, v83
  v_mfma_f32_16x16x32_bf16 v[180:183], a[172:175], v[100:103], v[180:183]
  ds_read_b128 a[148:151], v3 offset:4096
  v_cvt_pk_bf16_f32 v121, v82, v83
  v_mfma_f32_16x16x32_bf16 v[196:199], a[176:179], v[100:103], v[196:199]
  v_exp_f32 v84, v84
  v_mfma_f32_16x16x32_bf16 v[212:215], a[180:183], v[100:103], v[212:215]
  ds_read_b128 a[152:155], v4 offset:4096
  v_mfma_f32_16x16x32_bf16 v[228:231], a[184:187], v[100:103], v[228:231]
  v_exp_f32 v85, v85
  v_mfma_f32_16x16x32_bf16 v[244:247], a[188:191], v[100:103], v[244:247]
  v_exp_f32 v86, v86
  v_mfma_f32_16x16x32_bf16 v[52:55], a[192:195], v[100:103], v[52:55]
  ds_read_b128 a[156:159], v5 offset:4096
  v_cvt_pk_bf16_f32 v122, v84, v85
  v_mfma_f32_16x16x32_bf16 v[136:139], a[160:163], v[104:107], v[136:139]
  v_exp_f32 v87, v87
  v_mfma_f32_16x16x32_bf16 v[152:155], a[164:167], v[104:107], v[152:155]
  v_cvt_pk_bf16_f32 v123, v86, v87
  v_mfma_f32_16x16x32_bf16 v[168:171], a[168:171], v[104:107], v[168:171]
  v_exp_f32 v88, v88
  v_mfma_f32_16x16x32_bf16 v[184:187], a[172:175], v[104:107], v[184:187]
  v_mfma_f32_16x16x32_bf16 v[200:203], a[176:179], v[104:107], v[200:203]
  v_exp_f32 v89, v89
  v_mfma_f32_16x16x32_bf16 v[216:219], a[180:183], v[104:107], v[216:219]
  v_cvt_pk_bf16_f32 v124, v88, v89
  v_mfma_f32_16x16x32_bf16 v[232:235], a[184:187], v[104:107], v[232:235]
  v_exp_f32 v90, v90
  v_mfma_f32_16x16x32_bf16 v[248:251], a[188:191], v[104:107], v[248:251]
  v_mfma_f32_16x16x32_bf16 v[56:59], a[192:195], v[104:107], v[56:59]
  v_exp_f32 v91, v91
  v_mfma_f32_16x16x32_bf16 v[140:143], a[160:163], v[108:111], v[140:143]
  v_exp_f32 v92, v92
  v_mfma_f32_16x16x32_bf16 v[156:159], a[164:167], v[108:111], v[156:159]
  s_bitcmp1_b32 0x300, s30
  v_cvt_pk_bf16_f32 v125, v90, v91
  s_cbranch_scc1 L_os0
L_os0_e:
  v_mfma_f32_16x16x32_bf16 v[172:175], a[168:171], v[108:111], v[172:175]
  v_exp_f32 v93, v93
  v_mfma_f32_16x16x32_bf16 v[188:191], a[172:175], v[108:111], v[188:191]
  v_cvt_pk_bf16_f32 v126, v92, v93
  v_mfma_f32_16x16x32_bf16 v[204:207], a[176:179], v[108:111], v[204:207]
  v_exp_f32 v94, v94
  v_mfma_f32_16x16x32_bf16 v[220:223], a[180:183], v[108:111], v[220:223]
  v_mfma_f32_16x16x32_bf16 v[236:239], a[184:187], v[108:111], v[236:239]
  v_exp_f32 v95, v95
  v_mfma_f32_16x16x32_bf16 v[252:255], a[188:191], v[108:111], v[252:255]
  v_cvt_pk_bf16_f32 v127, v94, v95
  v_mfma_f32_16x16x32_bf16 v[60:63], a[192:195], v[108:111], v[60:63]
  s_waitcnt lgkmcnt(0)
  v_mfma_f32_16x16x32_bf16 v[64:67], a[128:131], a[0:3], v[32:35]
  s_add_u32 m0, s65, 0x10000
  ds_read_b64_tr_b16 a[160:161], v6 offset:8192
  v_mfma_f32_16x16x32_bf16 v[64:67], a[132:135], a[16:19], v[64:67]
  ds_read_b64_tr_b16 a[162:163], v6 offset:12288
  buffer_load_dwordx4 v18, s[8:11], s27 offen offset:0 nt lds
  v_mfma_f32_16x16x32_bf16 v[64:67], a[136:139], a[32:35], v[64:67]
  ds_read_b64_tr_b16 a[164:165], v7 offset:8192
  v_mfma_f32_16x16x32_bf16 v[64:67], a[140:143], a[48:51], v[64:67]
  ds_read_b64_tr_b16 a[166:167], v7 offset:12288
  buffer_load_dwordx4 v19, s[8:11], s27 offen offset:1024 nt lds
  v_mfma_f32_16x16x32_bf16 v[68:71], a[144:147], a[0:3], v[32:35]
  ds_read_b64_tr_b16 a[168:169], v8 offset:8192
  v_mfma_f32_16x16x32_bf16 v[68:71], a[148:151], a[16:19], v[68:71]
  ds_read_b64_tr_b16 a[170:171], v8 offset:12288
  buffer_load_dwordx4 v18, s[8:11], s27 offen offset:2048 nt lds
  v_mfma_f32_16x16x32_bf16 v[68:71], a[152:155], a[32:35], v[68:71]
  ds_read_b64_tr_b16 a[172:173], v9 offset:8192
  v_mfma_f32_16x16x32_bf16 v[68:71], a[156:159], a[48:51], v[68:71]
  ds_read_b64_tr_b16 a[174:175], v9 offset:12288
  buffer_load_dwordx4 v19, s[8:11], s27 offen offset:3072 nt lds
  v_mfma_f32_16x16x32_bf16 v[72:75], a[128:131], a[4:7], v[36:39]
  s_add_u32 s65, s65, 0x4000
  s_and_b32 s65, s65, 0xffff
  v_exp_f32 v64, v64
  v_mfma_f32_16x16x32_bf16 v[72:75], a[132:135], a[20:23], v[72:75]
  s_add_u32 s27, s27, 0x4000
  ds_read_b64_tr_b16 a[176:177], v10 offset:8192
  v_mfma_f32_16x16x32_bf16 v[72:75], a[136:139], a[36:39], v[72:75]
  v_exp_f32 v65, v65
  v_mfma_f32_16x16x32_bf16 v[72:75], a[140:143], a[52:55], v[72:75]
  ds_read_b64_tr_b16 a[178:179], v10 offset:12288
  v_cvt_pk_bf16_f32 v96, v64, v65
  v_mfma_f32_16x16x32_bf16 v[76:79], a[144:147], a[4:7], v[36:39]
  v_exp_f32 v66, v66
  v_mfma_f32_16x16x32_bf16 v[76:79], a[148:151], a[20:23], v[76:79]
  ds_read_b64_tr_b16 a[180:181], v11 offset:8192
  v_mfma_f32_16x16x32_bf16 v[76:79], a[152:155], a[36:39], v[76:79]
  v_exp_f32 v67, v67
  v_mfma_f32_16x16x32_bf16 v[76:79], a[156:159], a[52:55], v[76:79]
  v_exp_f32 v68, v68
  v_mfma_f32_16x16x32_bf16 v[80:83], a[128:131], a[8:11], v[40:43]
  ds_read_b64_tr_b16 a[182:183], v11 offset:12288
  v_cvt_pk_bf16_f32 v97, v66, v67
  v_mfma_f32_16x16x32_bf16 v[80:83], a[132:135], a[24:27], v[80:83]
  v_exp_f32 v69, v69
  v_mfma_f32_16x16x32_bf16 v[80:83], a[136:139], a[40:43], v[80:83]
  ds_read_b64_tr_b16 a[184:185], v12 offset:8192
  v_cvt_pk_bf16_f32 v98, v68, v69
  v_mfma_f32_16x16x32_bf16 v[80:83], a[140:143], a[56:59], v[80:83]
  v_exp_f32 v70, v70
  v_mfma_f32_16x16x32_bf16 v[84:87], a[144:147], a[8:11], v[40:43]
  ds_read_b64_tr_b16 a[186:187], v12 offset:12288
  v_mfma_f32_16x16x32_bf16 v[84:87], a[148:151], a[24:27], v[84:87]
  v_exp_f32 v71, v71
  v_mfma_f32_16x16x32_bf16 v[84:87], a[152:155], a[40:43], v[84:87]
  ds_read_b64_tr_b16 a[188:189], v13 offset:8192
  v_cvt_pk_bf16_f32 v99, v70, v71
  v_mfma_f32_16x16x32_bf16 v[84:87], a[156:159], a[56:59], v[84:87]
  v_exp_f32 v72, v72
  v_mfma_f32_16x16x32_bf16 v[88:91], a[128:131], a[12:15], v[44:47]
  ds_read_b64_tr_b16 a[190:191], v13 offset:12288
  v_mfma_f32_16x16x32_bf16 v[88:91], a[132:135], a[28:31], v[88:91]
  v_exp_f32 v73, v73
  v_mfma_f32_16x16x32_bf16 v[88:91], a[136:139], a[44:47], v[88:91]
  v_exp_f32 v74, v74
  v_mfma_f32_16x16x32_bf16 v[88:91], a[140:143], a[60:63], v[88:91]
  v_cvt_pk_bf16_f32 v100, v72, v73
  v_mfma_f32_16x16x32_bf16 v[92:95], a[144:147], a[12:15], v[44:47]
  v_exp_f32 v75, v75
  v_mfma_f32_16x16x32_bf16 v[92:95], a[148:151], a[28:31], v[92:95]
  v_cvt_pk_bf16_f32 v101, v74, v75
  v_mfma_f32_16x16x32_bf16 v[92:95], a[152:155], a[44:47], v[92:95]
  v_exp_f32 v76, v76
  v_mfma_f32_16x16x32_bf16 v[92:95], a[156:159], a[60:63], v[92:95]
  s_waitcnt lgkmcnt(0)
  v_mfma_f32_16x16x32_bf16 v[128:131], a[160:163], v[112:115], v[128:131]
  v_exp_f32 v77, v77
  v_mfma_f32_16x16x32_bf16 v[144:147], a[164:167], v[112:115], v[144:147]
  ds_read_b128 a[128:131], v2 offset:8192
  v_cvt_pk_bf16_f32 v102, v76, v77
  v_mfma_f32_16x16x32_bf16 v[160:163], a[168:171], v[112:115], v[160:163]
  v_exp_f32 v78, v78
  v_mfma_f32_16x16x32_bf16 v[176:179], a[172:175], v[112:115], v[176:179]
  ds_read_b128 a[132:135], v3 offset:8192
  v_mfma_f32_16x16x32_bf16 v[192:195], a[176:179], v[112:115], v[192:195]
  v_exp_f32 v79, v79
  v_mfma_f32_16x16x32_bf16 v[208:211], a[180:183], v[112:115], v[208:211]
  v_exp_f32 v80, v80
  v_mfma_f32_16x16x32_bf16 v[224:227], a[184:187], v[112:115], v[224:227]
  ds_read_b128 a[136:139], v4 offset:8192
  v_cvt_pk_bf16_f32 v103, v78, v79
  v_mfma_f32_16x16x32_bf16 v[240:243], a[188:191], v[112:115], v[240:243]
  v_exp_f32 v81, v81
  v_mfma_f32_16x16x32_bf16 v[48:51], a[192:195], v[112:115], v[48:51]
  ds_read_b128 a[140:143], v5 offset:8192
  v_cvt_pk_bf16_f32 v104, v80, v81
  v_mfma_f32_16x16x32_bf16 v[132:135], a[160:163], v[116:119], v[132:135]
  v_exp_f32 v82, v82
  v_mfma_f32_16x16x32_bf16 v[148:151], a[164:167], v[116:119], v[148:151]
  ds_read_b128 a[144:147], v2 offset:12288
  v_mfma_f32_16x16x32_bf16 v[164:167], a[168:171], v[116:119], v[164:167]
  v_exp_f32 v83, v83
  v_mfma_f32_16x16x32_bf16 v[180:183], a[172:175], v[116:119], v[180:183]
  ds_read_b128 a[148:151], v3 offset:12288
  v_cvt_pk_bf16_f32 v105, v82, v83
  v_mfma_f32_16x16x32_bf16 v[196:199], a[176:179], v[116:119], v[196:199]
  v_exp_f32 v84, v84
  v_mfma_f32_16x16x32_bf16 v[212:215], a[180:183], v[116:119], v[212:215]
  ds_read_b128 a[152:155], v4 offset:12288
  v_mfma_f32_16x16x32_bf16 v[228:231], a[184:187], v[116:119], v[228:231]
  v_exp_f32 v85, v85
  v_mfma_f32_16x16x32_bf16 v[244:247], a[188:191], v[116:119], v[244:247]
  v_exp_f32 v86, v86
  v_mfma_f32_16x16x32_bf16 v[52:55], a[192:195], v[116:119], v[52:55]
  ds_read_b128 a[156:159], v5 offset:12288
  v_cvt_pk_bf16_f32 v106, v84, v85
  v_mfma_f32_16x16x32_bf16 v[136:139], a[160:163], v[120:123], v[136:139]
  v_exp_f32 v87, v87
  v_mfma_f32_16x16x32_bf16 v[152:155], a[164:167], v[120:123], v[152:155]
  v_cvt_pk_bf16_f32 v107, v86, v87
  v_mfma_f32_16x16x32_bf16 v[168:171], a[168:171], v[120:123], v[168:171]
  v_exp_f32 v88, v88
  v_mfma_f32_16x16x32_bf16 v[184:187], a[172:175], v[120:123], v[184:187]
  s_waitcnt vmcnt(16) lgkmcnt(0)
  ds_add_u32 v30, a255
  v_mfma_f32_16x16x32_bf16 v[200:203], a[176:179], v[120:123], v[200:203]
  v_exp_f32 v89, v89
  v_mfma_f32_16x16x32_bf16 v[216:219], a[180:183], v[120:123], v[216:219]
  v_cvt_pk_bf16_f32 v108, v88, v89
  v_mfma_f32_16x16x32_bf16 v[232:235], a[184:187], v[120:123], v[232:235]
  v_exp_f32 v90, v90
  v_mfma_f32_16x16x32_bf16 v[248:251], a[188:191], v[120:123], v[248:251]
  v_mfma_f32_16x16x32_bf16 v[56:59], a[192:195], v[120:123], v[56:59]
  v_exp_f32 v91, v91
  v_mfma_f32_16x16x32_bf16 v[140:143], a[160:163], v[124:127], v[140:143]
  v_exp_f32 v92, v92
  v_mfma_f32_16x16x32_bf16 v[156:159], a[164:167], v[124:127], v[156:159]
  s_bitcmp1_b32 0x300, s30
  ds_read_b32 v0, v30
  v_cvt_pk_bf16_f32 v109, v90, v91
  s_cbranch_scc1 L_os1
L_os1_e:
  v_mfma_f32_16x16x32_bf16 v[172:175], a[168:171], v[124:127], v[172:175]
  v_exp_f32 v93, v93
  v_mfma_f32_16x16x32_bf16 v[188:191], a[172:175], v[124:127], v[188:191]
  v_cvt_pk_bf16_f32 v110, v92, v93
  v_mfma_f32_16x16x32_bf16 v[204:207], a[176:179], v[124:127], v[204:207]
  v_exp_f32 v94, v94
  v_mfma_f32_16x16x32_bf16 v[220:223], a[180:183], v[124:127], v[220:223]
  v_mfma_f32_16x16x32_bf16 v[236:239], a[184:187], v[124:127], v[236:239]
  v_exp_f32 v95, v95
  v_mfma_f32_16x16x32_bf16 v[252:255], a[188:191], v[124:127], v[252:255]
  s_waitcnt lgkmcnt(0)
  v_cmp_gt_u32 vcc, s68, v0
  v_cvt_pk_bf16_f32 v111, v94, v95
  v_mfma_f32_16x16x32_bf16 v[60:63], a[192:195], v[124:127], v[60:63]
  s_cbranch_vccnz L_spin7
L_spin7_ret:
  s_add_u32 s68, s68, 4
  s_waitcnt lgkmcnt(0)
  v_mfma_f32_16x16x32_bf16 v[64:67], a[128:131], a[0:3], v[32:35]
  s_mov_b32 m0, s29
  ds_read_b64_tr_b16 a[160:161], v6 offset:16384
  v_mfma_f32_16x16x32_bf16 v[64:67], a[132:135], a[16:19], v[64:67]
  ds_read_b64_tr_b16 a[162:163], v6 offset:20480
  buffer_load_dwordx4 v14, s[4:7], s26 offen offset:0 nt lds
  v_mfma_f32_16x16x32_bf16 v[64:67], a[136:139], a[32:35], v[64:67]
  ds_read_b64_tr_b16 a[164:165], v7 offset:16384
  v_mfma_f32_16x16x32_bf16 v[64:67], a[140:143], a[48:51], v[64:67]
  ds_read_b64_tr_b16 a[166:167], v7 offset:20480
  buffer_load_dwordx4 v15, s[4:7], s26 offen offset:1024 nt lds
  v_mfma_f32_16x16x32_bf16 v[68:71], a[144:147], a[0:3], v[32:35]
  ds_read_b64_tr_b16 a[168:169], v8 offset:16384
  v_mfma_f32_16x16x32_bf16 v[68:71], a[148:151], a[16:19], v[68:71]
  ds_read_b64_tr_b16 a[170:171], v8 offset:20480
  buffer_load_dwordx4 v16, s[4:7], s26 offen offset:2048 nt lds
  v_mfma_f32_16x16x32_bf16 v[68:71], a[152:155], a[32:35], v[68:71]
  ds_read_b64_tr_b16 a[172:173], v9 offset:16384
  v_mfma_f32_16x16x32_bf16 v[68:71], a[156:159], a[48:51], v[68:71]
  ds_read_b64_tr_b16 a[174:175], v9 offset:20480
  buffer_load_dwordx4 v17, s[4:7], s26 offen offset:3072 nt lds
  v_mfma_f32_16x16x32_bf16 v[72:75], a[128:131], a[4:7], v[36:39]
  s_add_u32 s29, s29, 0x4000
  s_and_b32 s29, s29, 0xffff
  v_exp_f32 v64, v64
  v_mfma_f32_16x16x32_bf16 v[72:75], a[132:135], a[20:23], v[72:75]
  s_add_u32 s26, s26, 0x4000
  ds_read_b64_tr_b16 a[176:177], v10 offset:16384
  v_mfma_f32_16x16x32_bf16 v[72:75], a[136:139], a[36:39], v[72:75]
  v_exp_f32 v65, v65
  v_mfma_f32_16x16x32_bf16 v[72:75], a[140:143], a[52:55], v[72:75]
  ds_read_b64_tr_b16 a[178:179], v10 offset:20480
  v_cvt_pk_bf16_f32 v112, v64, v65
  v_mfma_f32_16x16x32_bf16 v[76:79], a[144:147], a[4:7], v[36:39]
  v_exp_f32 v66, v66
  v_mfma_f32_16x16x32_bf16 v[76:79], a[148:151], a[20:23], v[76:79]
  ds_read_b64_tr_b16 a[180:181], v11 offset:16384
  v_mfma_f32_16x16x32_bf16 v[76:79], a[152:155], a[36:39], v[76:79]
  v_exp_f32 v67, v67
  v_mfma_f32_16x16x32_bf16 v[76:79], a[156:159], a[52:55], v[76:79]
  v_exp_f32 v68, v68
  v_mfma_f32_16x16x32_bf16 v[80:83], a[128:131], a[8:11], v[40:43]
  ds_read_b64_tr_b16 a[182:183], v11 offset:20480
  v_cvt_pk_bf16_f32 v113, v66, v67
  v_mfma_f32_16x16x32_bf16 v[80:83], a[132:135], a[24:27], v[80:83]
  v_exp_f32 v69, v69
  v_mfma_f32_16x16x32_bf16 v[80:83], a[136:139], a[40:43], v[80:83]
  ds_read_b64_tr_b16 a[184:185], v12 offset:16384
  v_cvt_pk_bf16_f32 v114, v68, v69
  v_mfma_f32_16x16x32_bf16 v[80:83], a[140:143], a[56:59], v[80:83]
  v_exp_f32 v70, v70
  v_mfma_f32_16x16x32_bf16 v[84:87], a[144:147], a[8:11], v[40:43]
  ds_read_b64_tr_b16 a[186:187], v12 offset:20480
  v_mfma_f32_16x16x32_bf16 v[84:87], a[148:151], a[24:27], v[84:87]
  v_exp_f32 v71, v71
  v_mfma_f32_16x16x32_bf16 v[84:87], a[152:155], a[40:43], v[84:87]
  ds_read_b64_tr_b16 a[188:189], v13 offset:16384
  v_cvt_pk_bf16_f32 v115, v70, v71
  v_mfma_f32_16x16x32_bf16 v[84:87], a[156:159], a[56:59], v[84:87]
  v_exp_f32 v72, v72
  v_mfma_f32_16x16x32_bf16 v[88:91], a[128:131], a[12:15], v[44:47]
  ds_read_b64_tr_b16 a[190:191], v13 offset:20480
  v_mfma_f32_16x16x32_bf16 v[88:91], a[132:135], a[28:31], v[88:91]
  v_exp_f32 v73, v73
  v_mfma_f32_16x16x32_bf16 v[88:91], a[136:139], a[44:47], v[88:91]
  v_exp_f32 v74, v74
  v_mfma_f32_16x16x32_bf16 v[88:91], a[140:143], a[60:63], v[88:91]
  v_cvt_pk_bf16_f32 v116, v72, v73
  v_mfma_f32_16x16x32_bf16 v[92:95], a[144:147], a[12:15], v[44:47]
  v_exp_f32 v75, v75
  v_mfma_f32_16x16x32_bf16 v[92:95], a[148:151], a[28:31], v[92:95]
  v_cvt_pk_bf16_f32 v117, v74, v75
  v_mfma_f32_16x16x32_bf16 v[92:95], a[152:155], a[44:47], v[92:95]
  v_exp_f32 v76, v76
  v_mfma_f32_16x16x32_bf16 v[92:95], a[156:159], a[60:63], v[92:95]
  s_waitcnt lgkmcnt(0)
  v_mfma_f32_16x16x32_bf16 v[128:131], a[160:163], v[96:99], v[128:131]
  v_exp_f32 v77, v77
  v_mfma_f32_16x16x32_bf16 v[144:147], a[164:167], v[96:99], v[144:147]
  ds_read_b128 a[128:131], v2 offset:16384
  v_cvt_pk_bf16_f32 v118, v76, v77
  v_mfma_f32_16x16x32_bf16 v[160:163], a[168:171], v[96:99], v[160:163]
  v_exp_f32 v78, v78
  v_mfma_f32_16x16x32_bf16 v[176:179], a[172:175], v[96:99], v[176:179]
  ds_read_b128 a[132:135], v3 offset:16384
  v_mfma_f32_16x16x32_bf16 v[192:195], a[176:179], v[96:99], v[192:195]
  v_exp_f32 v79, v79
  v_mfma_f32_16x16x32_bf16 v[208:211], a[180:183], v[96:99], v[208:211]
  v_exp_f32 v80, v80
  v_mfma_f32_16x16x32_bf16 v[224:227], a[184:187], v[96:99], v[224:227]
  ds_read_b128 a[136:139], v4 offset:16384
  v_cvt_pk_bf16_f32 v119, v78, v79
  v_mfma_f32_16x16x32_bf16 v[240:243], a[188:191], v[96:99], v[240:243]
  v_exp_f32 v81, v81
  v_mfma_f32_16x16x32_bf16 v[48:51], a[192:195], v[96:99], v[48:51]
  ds_read_b128 a[140:143], v5 offset:16384
  v_cvt_pk_bf16_f32 v120, v80, v81
  v_mfma_f32_16x16x32_bf16 v[132:135], a[160:163], v[100:103], v[132:135]
  v_exp_f32 v82, v82
  v_mfma_f32_16x16x32_bf16 v[148:151], a[164:167], v[100:103], v[148:151]
  ds_read_b128 a[144:147], v2 offset:20480
  v_mfma_f32_16x16x32_bf16 v[164:167], a[168:171], v[100:103], v[164:167]
  v_exp_f32 v83, v83
  v_mfma_f32_16x16x32_bf16 v[180:183], a[172:175], v[100:103], v[180:183]
  ds_read_b128 a[148:151], v3 offset:20480
  v_cvt_pk_bf16_f32 v121, v82, v83
  v_mfma_f32_16x16x32_bf16 v[196:199], a[176:179], v[100:103], v[196:199]
  v_exp_f32 v84, v84
  v_mfma_f32_16x16x32_bf16 v[212:215], a[180:183], v[100:103], v[212:215]
  ds_read_b128 a[152:155], v4 offset:20480
  v_mfma_f32_16x16x32_bf16 v[228:231], a[184:187], v[100:103], v[228:231]
  v_exp_f32 v85, v85
  v_mfma_f32_16x16x32_bf16 v[244:247], a[188:191], v[100:103], v[244:247]
  v_exp_f32 v86, v86
  v_mfma_f32_16x16x32_bf16 v[52:55], a[192:195], v[100:103], v[52:55]
  ds_read_b128 a[156:159], v5 offset:20480
  v_cvt_pk_bf16_f32 v122, v84, v85
  v_mfma_f32_16x16x32_bf16 v[136:139], a[160:163], v[104:107], v[136:139]
  v_exp_f32 v87, v87
  v_mfma_f32_16x16x32_bf16 v[152:155], a[164:167], v[104:107], v[152:155]
  v_cvt_pk_bf16_f32 v123, v86, v87
  v_mfma_f32_16x16x32_bf16 v[168:171], a[168:171], v[104:107], v[168:171]
  v_exp_f32 v88, v88
  v_mfma_f32_16x16x32_bf16 v[184:187], a[172:175], v[104:107], v[184:187]
  v_mfma_f32_16x16x32_bf16 v[200:203], a[176:179], v[104:107], v[200:203]
  v_exp_f32 v89, v89
  v_mfma_f32_16x16x32_bf16 v[216:219], a[180:183], v[104:107], v[216:219]
  v_cvt_pk_bf16_f32 v124, v88, v89
  v_mfma_f32_16x16x32_bf16 v[232:235], a[184:187], v[104:107], v[232:235]
  v_exp_f32 v90, v90
  v_mfma_f32_16x16x32_bf16 v[248:251], a[188:191], v[104:107], v[248:251]
  v_mfma_f32_16x16x32_bf16 v[56:59], a[192:195], v[104:107], v[56:59]
  v_exp_f32 v91, v91
  v_mfma_f32_16x16x32_bf16 v[140:143], a[160:163], v[108:111], v[140:143]
  v_exp_f32 v92, v92
  v_mfma_f32_16x16x32_bf16 v[156:159], a[164:167], v[108:111], v[156:159]
  s_bitcmp1_b32 0x300, s30
  v_cvt_pk_bf16_f32 v125, v90, v91
  s_cbranch_scc1 L_os2
L_os2_e:
  v_mfma_f32_16x16x32_bf16 v[172:175], a[168:171], v[108:111], v[172:175]
  v_exp_f32 v93, v93
  v_mfma_f32_16x16x32_bf16 v[188:191], a[172:175], v[108:111], v[188:191]
  v_cvt_pk_bf16_f32 v126, v92, v93
  v_mfma_f32_16x16x32_bf16 v[204:207], a[176:179], v[108:111], v[204:207]
  v_exp_f32 v94, v94
  v_mfma_f32_16x16x32_bf16 v[220:223], a[180:183], v[108:111], v[220:223]
  v_mfma_f32_16x16x32_bf16 v[236:239], a[184:187], v[108:111], v[236:239]
  v_exp_f32 v95, v95
  v_mfma_f32_16x16x32_bf16 v[252:255], a[188:191], v[108:111], v[252:255]
  v_cvt_pk_bf16_f32 v127, v94, v95
  v_mfma_f32_16x16x32_bf16 v[60:63], a[192:195], v[108:111], v[60:63]
  s_waitcnt lgkmcnt(0)
  s_bitcmp1_b32 0x8080, s30
  s_cbranch_scc1 L_pos3x
  v_mfma_f32_16x16x32_bf16 v[64:67], a[128:131], a[0:3], v[32:35]
  s_add_u32 m0, s65, 0x10000
  ds_read_b64_tr_b16 a[160:161], v6 offset:24576
  v_mfma_f32_16x16x32_bf16 v[64:67], a[132:135], a[16:19], v[64:67]
  ds_read_b64_tr_b16 a[162:163], v6 offset:28672
  buffer_load_dwordx4 v18, s[8:11], s27 offen offset:0 nt lds
  v_mfma_f32_16x16x32_bf16 v[64:67], a[136:139], a[32:35], v[64:67]
  ds_read_b64_tr_b16 a[164:165], v7 offset:24576
  v_mfma_f32_16x16x32_bf16 v[64:67], a[140:143], a[48:51], v[64:67]
  ds_read_b64_tr_b16 a[166:167], v7 offset:28672
  buffer_load_dwordx4 v19, s[8:11], s27 offen offset:1024 nt lds
  v_mfma_f32_16x16x32_bf16 v[68:71], a[144:147], a[0:3], v[32:35]
  ds_read_b64_tr_b16 a[168:169], v8 offset:24576
  v_mfma_f32_16x16x32_bf16 v[68:71], a[148:151], a[16:19], v[68:71]
  ds_read_b64_tr_b16 a[170:171], v8 offset:28672
  buffer_load_dwordx4 v18, s[8:11], s27 offen offset:2048 nt lds
  v_mfma_f32_16x16x32_bf16 v[68:71], a[152:155], a[32:35], v[68:71]
  ds_read_b64_tr_b16 a[172:173], v9 offset:24576
  v_mfma_f32_16x16x32_bf16 v[68:71], a[156:159], a[48:51], v[68:71]
  ds_read_b64_tr_b16 a[174:175], v9 offset:28672
  buffer_load_dwordx4 v19, s[8:11], s27 offen offset:3072 nt lds
  v_mfma_f32_16x16x32_bf16 v[72:75], a[128:131], a[4:7], v[36:39]
  s_add_u32 s65, s65, 0x4000
  s_and_b32 s65, s65, 0xffff
  v_exp_f32 v64, v64
  v_mfma_f32_16x16x32_bf16 v[72:75], a[132:135], a[20:23], v[72:75]
  s_add_u32 s27, s27, 0x4000
  ds_read_b64_tr_b16 a[176:177], v10 offset:24576
  v_mfma_f32_16x16x32_bf16 v[72:75], a[136:139], a[36:39], v[72:75]
  v_exp_f32 v65, v65
  v_mfma_f32_16x16x32_bf16 v[72:75], a[140:143], a[52:55], v[72:75]
  ds_read_b64_tr_b16 a[178:179], v10 offset:28672
  v_cvt_pk_bf16_f32 v96, v64, v65
  v_mfma_f32_16x16x32_bf16 v[76:79], a[144:147], a[4:7], v[36:39]
  v_exp_f32 v66, v66
  v_mfma_f32_16x16x32_bf16 v[76:79], a[148:151], a[20:23], v[76:79]
  ds_read_b64_tr_b16 a[180:181], v11 offset:24576
  v_mfma_f32_16x16x32_bf16 v[76:79], a[152:155], a[36:39], v[76:79]
  v_exp_f32 v67, v67
  v_mfma_f32_16x16x32_bf16 v[76:79], a[156:159], a[52:55], v[76:79]
  v_exp_f32 v68, v68
  v_mfma_f32_16x16x32_bf16 v[80:83], a[128:131], a[8:11], v[40:43]
  ds_read_b64_tr_b16 a[182:183], v11 offset:28672
  v_cvt_pk_bf16_f32 v97, v66, v67
  v_mfma_f32_16x16x32_bf16 v[80:83], a[132:135], a[24:27], v[80:83]
  v_exp_f32 v69, v69
  v_mfma_f32_16x16x32_bf16 v[80:83], a[136:139], a[40:43], v[80:83]
  ds_read_b64_tr_b16 a[184:185], v12 offset:24576
  v_cvt_pk_bf16_f32 v98, v68, v69
  v_mfma_f32_16x16x32_bf16 v[80:83], a[140:143], a[56:59], v[80:83]
  v_exp_f32 v70, v70
  v_mfma_f32_16x16x32_bf16 v[84:87], a[144:147], a[8:11], v[40:43]
  ds_read_b64_tr_b16 a[186:187], v12 offset:28672
  v_mfma_f32_16x16x32_bf16 v[84:87], a[148:151], a[24:27], v[84:87]
  v_exp_f32 v71, v71
  v_mfma_f32_16x16x32_bf16 v[84:87], a[152:155], a[40:43], v[84:87]
  ds_read_b64_tr_b16 a[188:189], v13 offset:24576
  v_cvt_pk_bf16_f32 v99, v70, v71
  v_mfma_f32_16x16x32_bf16 v[84:87], a[156:159], a[56:59], v[84:87]
  v_exp_f32 v72, v72
  v_mfma_f32_16x16x32_bf16 v[88:91], a[128:131], a[12:15], v[44:47]
  ds_read_b64_tr_b16 a[190:191], v13 offset:28672
  v_mfma_f32_16x16x32_bf16 v[88:91], a[132:135], a[28:31], v[88:91]
  v_exp_f32 v73, v73
  v_mfma_f32_16x16x32_bf16 v[88:91], a[136:139], a[44:47], v[88:91]
  v_exp_f32 v74, v74
  v_mfma_f32_16x16x32_bf16 v[88:91], a[140:143], a[60:63], v[88:91]
  v_cvt_pk_bf16_f32 v100, v72, v73
  v_mfma_f32_16x16x32_bf16 v[92:95], a[144:147], a[12:15], v[44:47]
  v_exp_f32 v75, v75
  v_mfma_f32_16x16x32_bf16 v[92:95], a[148:151], a[28:31], v[92:95]
  v_cvt_pk_bf16_f32 v101, v74, v75
  v_xor_b32 v6, 0x8000, v6
  v_mfma_f32_16x16x32_bf16 v[92:95], a[152:155], a[44:47], v[92:95]
  v_exp_f32 v76, v76
  v_mfma_f32_16x16x32_bf16 v[92:95], a[156:159], a[60:63], v[92:95]
  s_waitcnt lgkmcnt(0)
  v_xor_b32 v7, 0x8000, v7
  v_xor_b32 v8, 0x8000, v8
  v_mfma_f32_16x16x32_bf16 v[128:131], a[160:163], v[112:115], v[128:131]
  v_exp_f32 v77, v77
  v_mfma_f32_16x16x32_bf16 v[144:147], a[164:167], v[112:115], v[144:147]
  ds_read_b128 a[128:131], v2 offset:24576
  v_cvt_pk_bf16_f32 v102, v76, v77
  v_mfma_f32_16x16x32_bf16 v[160:163], a[168:171], v[112:115], v[160:163]
  v_exp_f32 v78, v78
  v_mfma_f32_16x16x32_bf16 v[176:179], a[172:175], v[112:115], v[176:179]
  ds_read_b128 a[132:135], v3 offset:24576
  v_xor_b32 v9, 0x8000, v9
  v_mfma_f32_16x16x32_bf16 v[192:195], a[176:179], v[112:115], v[192:195]
  v_exp_f32 v79, v79
  v_mfma_f32_16x16x32_bf16 v[208:211], a[180:183], v[112:115], v[208:211]
  v_exp_f32 v80, v80
  v_mfma_f32_16x16x32_bf16 v[224:227], a[184:187], v[112:115], v[224:227]
  ds_read_b128 a[136:139], v4 offset:24576
  v_cvt_pk_bf16_f32 v103, v78, v79
  v_mfma_f32_16x16x32_bf16 v[240:243], a[188:191], v[112:115], v[240:243]
  v_exp_f32 v81, v81
  v_mfma_f32_16x16x32_bf16 v[48:51], a[192:195], v[112:115], v[48:51]
  ds_read_b128 a[140:143], v5 offset:24576
  v_cvt_pk_bf16_f32 v104, v80, v81
  v_mfma_f32_16x16x32_bf16 v[132:135], a[160:163], v[116:119], v[132:135]
  v_exp_f32 v82, v82
  v_mfma_f32_16x16x32_bf16 v[148:151], a[164:167], v[116:119], v[148:151]
  ds_read_b128 a[144:147], v2 offset:28672
  v_xor_b32 v10, 0x8000, v10
  v_mfma_f32_16x16x32_bf16 v[164:167], a[168:171], v[116:119], v[164:167]
  v_exp_f32 v83, v83
  v_mfma_f32_16x16x32_bf16 v[180:183], a[172:175], v[116:119], v[180:183]
  ds_read_b128 a[148:151], v3 offset:28672
  v_cvt_pk_bf16_f32 v105, v82, v83
  v_mfma_f32_16x16x32_bf16 v[196:199], a[176:179], v[116:119], v[196:199]
  v_exp_f32 v84, v84
  v_mfma_f32_16x16x32_bf16 v[212:215], a[180:183], v[116:119], v[212:215]
  ds_read_b128 a[152:155], v4 offset:28672
  v_xor_b32 v11, 0x8000, v11
  v_mfma_f32_16x16x32_bf16 v[228:231], a[184:187], v[116:119], v[228:231]
  v_exp_f32 v85, v85
  v_mfma_f32_16x16x32_bf16 v[244:247], a[188:191], v[116:119], v[244:247]
  v_exp_f32 v86, v86
  v_mfma_f32_16x16x32_bf16 v[52:55], a[192:195], v[116:119], v[52:55]
  ds_read_b128 a[156:159], v5 offset:28672
  v_cvt_pk_bf16_f32 v106, v84, v85
  v_mfma_f32_16x16x32_bf16 v[136:139], a[160:163], v[120:123], v[136:139]
  v_exp_f32 v87, v87
  v_mfma_f32_16x16x32_bf16 v[152:155], a[164:167], v[120:123], v[152:155]
  v_cvt_pk_bf16_f32 v107, v86, v87
  v_xor_b32 v12, 0x8000, v12
  v_mfma_f32_16x16x32_bf16 v[168:171], a[168:171], v[120:123], v[168:171]
  v_exp_f32 v88, v88
  v_mfma_f32_16x16x32_bf16 v[184:187], a[172:175], v[120:123], v[184:187]
  s_waitcnt vmcnt(16) lgkmcnt(0)
  ds_add_u32 v30, a255
  v_xor_b32 v13, 0x8000, v13
  v_mfma_f32_16x16x32_bf16 v[200:203], a[176:179], v[120:123], v[200:203]
  v_exp_f32 v89, v89
  v_mfma_f32_16x16x32_bf16 v[216:219], a[180:183], v[120:123], v[216:219]
  v_cvt_pk_bf16_f32 v108, v88, v89
  v_xor_b32 v2, 0x8000, v2
  v_mfma_f32_16x16x32_bf16 v[232:235], a[184:187], v[120:123], v[232:235]
  v_exp_f32 v90, v90
  v_mfma_f32_16x16x32_bf16 v[248:251], a[188:191], v[120:123], v[248:251]
  v_xor_b32 v3, 0x8000, v3
  v_xor_b32 v4, 0x8000, v4
  v_mfma_f32_16x16x32_bf16 v[56:59], a[192:195], v[120:123], v[56:59]
  v_exp_f32 v91, v91
  v_mfma_f32_16x16x32_bf16 v[140:143], a[160:163], v[124:127], v[140:143]
  v_exp_f32 v92, v92
  v_mfma_f32_16x16x32_bf16 v[156:159], a[164:167], v[124:127], v[156:159]
  s_bitcmp1_b32 0x300, s30
  ds_read_b32 v0, v30
  v_cvt_pk_bf16_f32 v109, v90, v91
  s_cbranch_scc1 L_os3
L_os3_e:
  v_mfma_f32_16x16x32_bf16 v[172:175], a[168:171], v[124:127], v[172:175]
  v_exp_f32 v93, v93
  v_mfma_f32_16x16x32_bf16 v[188:191], a[172:175], v[124:127], v[188:191]
  v_cvt_pk_bf16_f32 v110, v92, v93
  v_xor_b32 v5, 0x8000, v5
  v_mfma_f32_16x16x32_bf16 v[204:207], a[176:179], v[124:127], v[204:207]
  v_exp_f32 v94, v94
  v_mfma_f32_16x16x32_bf16 v[220:223], a[180:183], v[124:127], v[220:223]
  v_mfma_f32_16x16x32_bf16 v[236:239], a[184:187], v[124:127], v[236:239]
  v_exp_f32 v95, v95
  v_mfma_f32_16x16x32_bf16 v[252:255], a[188:191], v[124:127], v[252:255]
  s_waitcnt lgkmcnt(0)
  v_cmp_gt_u32 vcc, s68, v0
  v_cvt_pk_bf16_f32 v111, v94, v95
  v_mfma_f32_16x16x32_bf16 v[60:63], a[192:195], v[124:127], v[60:63]
  s_cbranch_vccnz L_spin8
L_spin8_ret:
  s_add_u32 s68, s68, 4
  s_waitcnt lgkmcnt(0)
  s_bitcmp1_b32 0x4400, s30
  s_cbranch_scc1 L_endit
L_endit_ret:
L_switch_ret:
  s_add_u32 s30, s30, 1
  s_branch L_aloop
L_os0:
  s_cmp_lg_u32 s30, 8
  s_cbranch_scc1 L_os0_1
  s_add_u32 s48, s31, 0x0
  buffer_store_dwordx4 a[64:67], v1, s[20:23], s48 offen offset:0 sc1
  s_add_u32 s48, s31, 0x0
  buffer_store_dwordx4 a[68:71], v1, s[20:23], s48 offen offset:1024 sc1
  s_branch L_os0_e
L_os0_1:
  s_add_u32 s48, s31, 0x8000
  buffer_store_dwordx4 a[96:99], v1, s[20:23], s48 offen offset:0 sc1
  s_add_u32 s48, s31, 0x8000
  buffer_store_dwordx4 a[100:103], v1, s[20:23], s48 offen offset:1024 sc1
  s_branch L_os0_e
L_os1:
  s_cmp_lg_u32 s30, 8
  s_cbranch_scc1 L_os1_1
  s_add_u32 s48, s31, 0x0
  buffer_store_dwordx4 a[72:75], v1, s[20:23], s48 offen offset:2048 sc1
  s_add_u32 s48, s31, 0x0
  buffer_store_dwordx4 a[76:79], v1, s[20:23], s48 offen offset:3072 sc1
  s_branch L_os1_e
L_os1_1:
  s_add_u32 s48, s31, 0x8000
  buffer_store_dwordx4 a[104:107], v1, s[20:23], s48 offen offset:2048 sc1
  s_add_u32 s48, s31, 0x8000
  buffer_store_dwordx4 a[108:111], v1, s[20:23], s48 offen offset:3072 sc1
  s_branch L_os1_e
L_os2:
  s_cmp_lg_u32 s30, 8
  s_cbranch_scc1 L_os2_1
  s_add_u32 s48, s31, 0x4000
  buffer_store_dwordx4 a[80:83], v1, s[20:23], s48 offen offset:0 sc1
  s_add_u32 s48, s31, 0x4000
  buffer_store_dwordx4 a[84:87], v1, s[20:23], s48 offen offset:1024 sc1
  s_branch L_os2_e
L_os2_1:
  s_add_u32 s48, s31, 0xc000
  buffer_store_dwordx4 a[112:115], v1, s[20:23], s48 offen offset:0 sc1
  s_add_u32 s48, s31, 0xc000
  buffer_store_dwordx4 a[116:119], v1, s[20:23], s48 offen offset:1024 sc1
  s_branch L_os2_e
L_os3:
  s_cmp_lg_u32 s30, 8
  s_cbranch_scc1 L_os3_1
  s_add_u32 s48, s31, 0x4000
  buffer_store_dwordx4 a[88:91], v1, s[20:23], s48 offen offset:2048 sc1
  s_add_u32 s48, s31, 0x4000
  buffer_store_dwordx4 a[92:95], v1, s[20:23], s48 offen offset:3072 sc1
  s_branch L_os3_e
L_os3_1:
  s_add_u32 s48, s31, 0xc000
  buffer_store_dwordx4 a[120:123], v1, s[20:23], s48 offen offset:2048 sc1
  s_add_u32 s48, s31, 0xc000
  buffer_store_dwordx4 a[124:127], v1, s[20:23], s48 offen offset:3072 sc1
  s_add_u32 s31, s31, 0x10000
  s_branch L_os3_e
L_pos3x:
  s_cmp_eq_u32 s30, 15
  s_cbranch_scc1 L_endp
  v_accvgpr_mov_b32 a0, a64
  v_accvgpr_mov_b32 a1, a65
  v_accvgpr_mov_b32 a2, a66
  v_accvgpr_mov_b32 a3, a67
  v_accvgpr_mov_b32 a4, a68
  v_accvgpr_mov_b32 a5, a69
  v_accvgpr_mov_b32 a6, a70
  v_accvgpr_mov_b32 a7, a71
  v_accvgpr_mov_b32 a8, a72
  v_accvgpr_mov_b32 a9, a73
  v_accvgpr_mov_b32 a10, a74
  v_accvgpr_mov_b32 a11, a75
  v_accvgpr_mov_b32 a12, a76
  v_accvgpr_mov_b32 a13, a77
  v_accvgpr_mov_b32 a14, a78
  v_accvgpr_mov_b32 a15, a79
  v_accvgpr_mov_b32 a16, a80
  v_accvgpr_mov_b32 a17, a81
  v_accvgpr_mov_b32 a18, a82
  v_accvgpr_mov_b32 a19, a83
  v_accvgpr_mov_b32 a20, a84
  v_accvgpr_mov_b32 a21, a85
  v_accvgpr_mov_b32 a22, a86
  v_accvgpr_mov_b32 a23, a87
  v_accvgpr_mov_b32 a24, a88
  v_accvgpr_mov_b32 a25, a89
  v_accvgpr_mov_b32 a26, a90
  v_accvgpr_mov_b32 a27, a91
  v_accvgpr_mov_b32 a28, a92
  v_accvgpr_mov_b32 a29, a93
  v_accvgpr_mov_b32 a30, a94
  v_accvgpr_mov_b32 a31, a95
  v_accvgpr_mov_b32 a32, a96
  v_accvgpr_mov_b32 a33, a97
  v_accvgpr_mov_b32 a34, a98
  v_accvgpr_mov_b32 a35, a99
  v_accvgpr_mov_b32 a36, a100
  v_accvgpr_mov_b32 a37, a101
  v_accvgpr_mov_b32 a38, a102
  v_accvgpr_mov_b32 a39, a103
  v_accvgpr_mov_b32 a40, a104
  v_accvgpr_mov_b32 a41, a105
  v_accvgpr_mov_b32 a42, a106
  v_accvgpr_mov_b32 a43, a107
  v_accvgpr_mov_b32 a44, a108
  v_accvgpr_mov_b32 a45, a109
  v_accvgpr_mov_b32 a46, a110
  v_accvgpr_mov_b32 a47, a111
  v_accvgpr_mov_b32 a48, a112
  v_accvgpr_mov_b32 a49, a113
  v_accvgpr_mov_b32 a50, a114
  v_accvgpr_mov_b32 a51, a115
  v_accvgpr_mov_b32 a52, a116
  v_accvgpr_mov_b32 a53, a117
  v_accvgpr_mov_b32 a54, a118
  v_accvgpr_mov_b32 a55, a119
  v_accvgpr_mov_b32 a56, a120
  v_accvgpr_mov_b32 a57, a121
  v_accvgpr_mov_b32 a58, a122
  v_accvgpr_mov_b32 a59, a123
  v_accvgpr_mov_b32 a60, a124
  v_accvgpr_mov_b32 a61, a125
  v_accvgpr_mov_b32 a62, a126
  v_accvgpr_mov_b32 a63, a127
  v_mfma_f32_16x16x32_bf16 v[64:67], a[128:131], a[0:3], 0
  s_add_u32 m0, s65, 0x10000
  ds_read_b64_tr_b16 a[160:161], v6 offset:24576
  v_mfma_f32_16x16x32_bf16 v[64:67], a[132:135], a[16:19], v[64:67]
  ds_read_b64_tr_b16 a[162:163], v6 offset:28672
  buffer_load_dwordx4 v18, s[8:11], s27 offen offset:0 nt lds
  v_mfma_f32_16x16x32_bf16 v[64:67], a[136:139], a[32:35], v[64:67]
  ds_read_b64_tr_b16 a[164:165], v7 offset:24576
  v_mfma_f32_16x16x32_bf16 v[64:67], a[140:143], a[48:51], v[64:67]
  ds_read_b64_tr_b16 a[166:167], v7 offset:28672
  buffer_load_dwordx4 v19, s[8:11], s27 offen offset:1024 nt lds
  v_mfma_f32_16x16x32_bf16 v[68:71], a[144:147], a[0:3], 0
  ds_read_b64_tr_b16 a[168:169], v8 offset:24576
  v_mfma_f32_16x16x32_bf16 v[68:71], a[148:151], a[16:19], v[68:71]
  ds_read_b64_tr_b16 a[170:171], v8 offset:28672
  buffer_load_dwordx4 v18, s[8:11], s27 offen offset:2048 nt lds
  v_mfma_f32_16x16x32_bf16 v[68:71], a[152:155], a[32:35], v[68:71]
  ds_read_b64_tr_b16 a[172:173], v9 offset:24576
  v_mfma_f32_16x16x32_bf16 v[68:71], a[156:159], a[48:51], v[68:71]
  ds_read_b64_tr_b16 a[174:175], v9 offset:28672
  buffer_load_dwordx4 v19, s[8:11], s27 offen offset:3072 nt lds
  v_mfma_f32_16x16x32_bf16 v[72:75], a[128:131], a[4:7], 0
  s_add_u32 s65, s65, 0x4000
  s_and_b32 s65, s65, 0xffff
  ds_read_b64_tr_b16 a[176:177], v10 offset:24576
  v_mfma_f32_16x16x32_bf16 v[72:75], a[132:135], a[20:23], v[72:75]
  s_add_u32 s27, s27, 0x4000
  ds_read_b64_tr_b16 a[178:179], v10 offset:28672
  v_mfma_f32_16x16x32_bf16 v[72:75], a[136:139], a[36:39], v[72:75]
  ds_read_b64_tr_b16 a[180:181], v11 offset:24576
  v_mfma_f32_16x16x32_bf16 v[72:75], a[140:143], a[52:55], v[72:75]
  ds_read_b64_tr_b16 a[182:183], v11 offset:28672
  v_max3_f32 v22, v64, v65, v66
  v_mfma_f32_16x16x32_bf16 v[76:79], a[144:147], a[4:7], 0
  ds_read_b64_tr_b16 a[184:185], v12 offset:24576
  v_max3_f32 v22, v22, v67, v68
  v_mfma_f32_16x16x32_bf16 v[76:79], a[148:151], a[20:23], v[76:79]
  ds_read_b64_tr_b16 a[186:187], v12 offset:28672
  v_max3_f32 v22, v22, v69, v70
  v_mfma_f32_16x16x32_bf16 v[76:79], a[152:155], a[36:39], v[76:79]
  ds_read_b64_tr_b16 a[188:189], v13 offset:24576
  v_max_f32 v22, v22, v71
  v_mfma_f32_16x16x32_bf16 v[76:79], a[156:159], a[52:55], v[76:79]
  ds_read_b64_tr_b16 a[190:191], v13 offset:28672
  v_mov_b32 v23, v22
  v_mfma_f32_16x16x32_bf16 v[80:83], a[128:131], a[8:11], 0
  s_nop 0
  v_permlane16_swap_b32 v22, v23
  v_max_f32 v22, v22, v23
  v_mfma_f32_16x16x32_bf16 v[80:83], a[132:135], a[24:27], v[80:83]
  v_mov_b32 v23, v22
  s_nop 1
  v_permlane32_swap_b32 v22, v23
  v_mfma_f32_16x16x32_bf16 v[80:83], a[136:139], a[40:43], v[80:83]
  v_max_f32 v22, v22, v23
  v_sub_f32 v32, 0, v22
  v_mfma_f32_16x16x32_bf16 v[80:83], a[140:143], a[56:59], v[80:83]
  v_sub_f32 v33, 0, v22
  v_sub_f32 v34, 0, v22
  v_mfma_f32_16x16x32_bf16 v[84:87], a[144:147], a[8:11], 0
  v_sub_f32 v35, 0, v22
  v_sub_f32 v64, v64, v22
  v_mfma_f32_16x16x32_bf16 v[84:87], a[148:151], a[24:27], v[84:87]
  v_sub_f32 v65, v65, v22
  v_sub_f32 v66, v66, v22
  v_mfma_f32_16x16x32_bf16 v[84:87], a[152:155], a[40:43], v[84:87]
  v_sub_f32 v67, v67, v22
  v_sub_f32 v68, v68, v22
  v_mfma_f32_16x16x32_bf16 v[84:87], a[156:159], a[56:59], v[84:87]
  v_sub_f32 v69, v69, v22
  v_sub_f32 v70, v70, v22
  v_mfma_f32_16x16x32_bf16 v[88:91], a[128:131], a[12:15], 0
  v_sub_f32 v71, v71, v22
  v_exp_f32 v64, v64
  v_mfma_f32_16x16x32_bf16 v[88:91], a[132:135], a[28:31], v[88:91]
  v_exp_f32 v65, v65
  v_mfma_f32_16x16x32_bf16 v[88:91], a[136:139], a[44:47], v[88:91]
  v_exp_f32 v66, v66
  v_mfma_f32_16x16x32_bf16 v[88:91], a[140:143], a[60:63], v[88:91]
  v_exp_f32 v67, v67
  v_mfma_f32_16x16x32_bf16 v[92:95], a[144:147], a[12:15], 0
  v_xor_b32 v6, 0x8000, v6
  v_xor_b32 v7, 0x8000, v7
  v_mfma_f32_16x16x32_bf16 v[92:95], a[148:151], a[28:31], v[92:95]
  v_xor_b32 v8, 0x8000, v8
  v_xor_b32 v9, 0x8000, v9
  v_mfma_f32_16x16x32_bf16 v[92:95], a[152:155], a[44:47], v[92:95]
  v_xor_b32 v10, 0x8000, v10
  v_xor_b32 v11, 0x8000, v11
  v_mfma_f32_16x16x32_bf16 v[92:95], a[156:159], a[60:63], v[92:95]
  s_waitcnt lgkmcnt(0)
  v_xor_b32 v12, 0x8000, v12
  v_xor_b32 v13, 0x8000, v13
  v_mfma_f32_16x16x32_bf16 v[128:131], a[160:163], v[112:115], v[128:131]
  ds_read_b128 a[128:131], v2 offset:24576
  v_exp_f32 v68, v68
  v_mfma_f32_16x16x32_bf16 v[144:147], a[164:167], v[112:115], v[144:147]
  ds_read_b128 a[132:135], v3 offset:24576
  v_exp_f32 v69, v69
  v_mfma_f32_16x16x32_bf16 v[160:163], a[168:171], v[112:115], v[160:163]
  ds_read_b128 a[136:139], v4 offset:24576
  v_exp_f32 v70, v70
  v_mfma_f32_16x16x32_bf16 v[176:179], a[172:175], v[112:115], v[176:179]
  ds_read_b128 a[140:143], v5 offset:24576
  v_exp_f32 v71, v71
  v_mfma_f32_16x16x32_bf16 v[192:195], a[176:179], v[112:115], v[192:195]
  ds_read_b128 a[144:147], v2 offset:28672
  v_cvt_pk_bf16_f32 v96, v64, v65
  v_mfma_f32_16x16x32_bf16 v[208:211], a[180:183], v[112:115], v[208:211]
  ds_read_b128 a[148:151], v3 offset:28672
  v_cvt_pk_bf16_f32 v97, v66, v67
  v_mfma_f32_16x16x32_bf16 v[224:227], a[184:187], v[112:115], v[224:227]
  ds_read_b128 a[152:155], v4 offset:28672
  v_cvt_pk_bf16_f32 v98, v68, v69
  v_mfma_f32_16x16x32_bf16 v[240:243], a[188:191], v[112:115], v[240:243]
  ds_read_b128 a[156:159], v5 offset:28672
  v_cvt_pk_bf16_f32 v99, v70, v71
  v_mfma_f32_16x16x32_bf16 v[48:51], a[192:195], v[112:115], v[48:51]
  v_max3_f32 v24, v72, v73, v74
  v_max3_f32 v24, v24, v75, v76
  v_mfma_f32_16x16x32_bf16 v[132:135], a[160:163], v[116:119], v[132:135]
  v_max3_f32 v24, v24, v77, v78
  v_max_f32 v24, v24, v79
  v_mfma_f32_16x16x32_bf16 v[148:151], a[164:167], v[116:119], v[148:151]
  v_mov_b32 v25, v24
  s_nop 1
  v_permlane16_swap_b32 v24, v25
  v_mfma_f32_16x16x32_bf16 v[164:167], a[168:171], v[116:119], v[164:167]
  v_max_f32 v24, v24, v25
  v_mov_b32 v25, v24
  v_mfma_f32_16x16x32_bf16 v[180:183], a[172:175], v[116:119], v[180:183]
  s_nop 0
  v_permlane32_swap_b32 v24, v25
  v_max_f32 v24, v24, v25
  v_mfma_f32_16x16x32_bf16 v[196:199], a[176:179], v[116:119], v[196:199]
  v_sub_f32 v36, 0, v24
  v_sub_f32 v37, 0, v24
  v_mfma_f32_16x16x32_bf16 v[212:215], a[180:183], v[116:119], v[212:215]
  v_sub_f32 v38, 0, v24
  v_sub_f32 v39, 0, v24
  v_mfma_f32_16x16x32_bf16 v[228:231], a[184:187], v[116:119], v[228:231]
  v_sub_f32 v72, v72, v24
  v_sub_f32 v73, v73, v24
  v_mfma_f32_16x16x32_bf16 v[244:247], a[188:191], v[116:119], v[244:247]
  v_sub_f32 v74, v74, v24
  v_sub_f32 v75, v75, v24
  v_mfma_f32_16x16x32_bf16 v[52:55], a[192:195], v[116:119], v[52:55]
  v_sub_f32 v76, v76, v24
  v_sub_f32 v77, v77, v24
  v_mfma_f32_16x16x32_bf16 v[136:139], a[160:163], v[120:123], v[136:139]
  v_sub_f32 v78, v78, v24
  v_sub_f32 v79, v79, v24
  v_mfma_f32_16x16x32_bf16 v[152:155], a[164:167], v[120:123], v[152:155]
  v_exp_f32 v72, v72
  v_mfma_f32_16x16x32_bf16 v[168:171], a[168:171], v[120:123], v[168:171]
  v_xor_b32 v2, 0x8000, v2
  v_xor_b32 v3, 0x8000, v3
  v_mfma_f32_16x16x32_bf16 v[184:187], a[172:175], v[120:123], v[184:187]
  s_waitcnt vmcnt(16) lgkmcnt(0)
  ds_add_u32 v30, a255
  v_xor_b32 v4, 0x8000, v4
  v_mfma_f32_16x16x32_bf16 v[200:203], a[176:179], v[120:123], v[200:203]
  v_xor_b32 v5, 0x8000, v5
  v_exp_f32 v73, v73
  v_mfma_f32_16x16x32_bf16 v[216:219], a[180:183], v[120:123], v[216:219]
  v_exp_f32 v74, v74
  v_mfma_f32_16x16x32_bf16 v[232:235], a[184:187], v[120:123], v[232:235]
  v_exp_f32 v75, v75
  v_mfma_f32_16x16x32_bf16 v[248:251], a[188:191], v[120:123], v[248:251]
  v_exp_f32 v76, v76
  v_mfma_f32_16x16x32_bf16 v[56:59], a[192:195], v[120:123], v[56:59]
  v_exp_f32 v77, v77
  v_mfma_f32_16x16x32_bf16 v[140:143], a[160:163], v[124:127], v[140:143]
  v_exp_f32 v78, v78
  v_mfma_f32_16x16x32_bf16 v[156:159], a[164:167], v[124:127], v[156:159]
  ds_read_b32 v0, v30
  v_exp_f32 v79, v79
  v_mfma_f32_16x16x32_bf16 v[172:175], a[168:171], v[124:127], v[172:175]
  v_cvt_pk_bf16_f32 v100, v72, v73
  v_cvt_pk_bf16_f32 v101, v74, v75
  v_mfma_f32_16x16x32_bf16 v[188:191], a[172:175], v[124:127], v[188:191]
  v_cvt_pk_bf16_f32 v102, v76, v77
  v_cvt_pk_bf16_f32 v103, v78, v79
  v_mfma_f32_16x16x32_bf16 v[204:207], a[176:179], v[124:127], v[204:207]
  v_max3_f32 v22, v80, v81, v82
  v_max3_f32 v22, v22, v83, v84
  v_mfma_f32_16x16x32_bf16 v[220:223], a[180:183], v[124:127], v[220:223]
  v_max3_f32 v22, v22, v85, v86
  v_max_f32 v22, v22, v87
  v_mfma_f32_16x16x32_bf16 v[236:239], a[184:187], v[124:127], v[236:239]
  v_mov_b32 v23, v22
  s_nop 1
  v_permlane16_swap_b32 v22, v23
  v_mfma_f32_16x16x32_bf16 v[252:255], a[188:191], v[124:127], v[252:255]
  s_waitcnt lgkmcnt(0)
  v_cmp_gt_u32 vcc, s68, v0
  v_max_f32 v22, v22, v23
  v_mfma_f32_16x16x32_bf16 v[60:63], a[192:195], v[124:127], v[60:63]
  v_mov_b32 v23, v22
  s_nop 1
  v_permlane32_swap_b32 v22, v23
  v_max_f32 v22, v22, v23
  v_sub_f32 v40, 0, v22
  v_sub_f32 v41, 0, v22
  v_sub_f32 v42, 0, v22
  v_sub_f32 v43, 0, v22
  v_sub_f32 v80, v80, v22
  v_sub_f32 v81, v81, v22
  v_sub_f32 v82, v82, v22
  v_sub_f32 v83, v83, v22
  v_sub_f32 v84, v84, v22
  v_sub_f32 v85, v85, v22
  v_sub_f32 v86, v86, v22
  v_sub_f32 v87, v87, v22
  v_exp_f32 v80, v80
  v_exp_f32 v81, v81
  v_exp_f32 v82, v82
  v_exp_f32 v83, v83
  v_exp_f32 v84, v84
  v_exp_f32 v85, v85
  v_exp_f32 v86, v86
  v_exp_f32 v87, v87
  v_cvt_pk_bf16_f32 v104, v80, v81
  v_cvt_pk_bf16_f32 v105, v82, v83
  v_cvt_pk_bf16_f32 v106, v84, v85
  v_cvt_pk_bf16_f32 v107, v86, v87
  v_max3_f32 v24, v88, v89, v90
  v_max3_f32 v24, v24, v91, v92
  v_max3_f32 v24, v24, v93, v94
  v_max_f32 v24, v24, v95
  v_mov_b32 v25, v24
  s_nop 0
  s_nop 0
  v_permlane16_swap_b32 v24, v25
  v_max_f32 v24, v24, v25
  v_mov_b32 v25, v24
  s_nop 0
  s_nop 0
  v_permlane32_swap_b32 v24, v25
  v_max_f32 v24, v24, v25
  v_sub_f32 v44, 0, v24
  v_sub_f32 v45, 0, v24
  v_sub_f32 v46, 0, v24
  v_sub_f32 v47, 0, v24
  v_sub_f32 v88, v88, v24
  v_sub_f32 v89, v89, v24
  v_sub_f32 v90, v90, v24
  v_sub_f32 v91, v91, v24
  v_sub_f32 v92, v92, v24
  v_sub_f32 v93, v93, v24
  v_sub_f32 v94, v94, v24
  v_sub_f32 v95, v95, v24
  v_exp_f32 v88, v88
  v_exp_f32 v89, v89
  v_exp_f32 v90, v90
  v_exp_f32 v91, v91
  v_exp_f32 v92, v92
  v_exp_f32 v93, v93
  v_exp_f32 v94, v94
  v_exp_f32 v95, v95
  v_cvt_pk_bf16_f32 v108, v88, v89
  v_cvt_pk_bf16_f32 v109, v90, v91
  v_cvt_pk_bf16_f32 v110, v92, v93
  v_cvt_pk_bf16_f32 v111, v94, v95
  s_cbranch_vccnz L_spin9
L_spin9_ret:
  s_add_u32 s68, s68, 4
  s_waitcnt lgkmcnt(0)
  s_nop 7
  v_mov_b32 v73, 0x4e800000
  v_rcp_f32 v64, v48
  v_rcp_f32 v66, v52
  v_rcp_f32 v68, v56
  v_rcp_f32 v70, v60
  v_cmp_nle_f32 s[48:49], v48, v73
  v_cmp_nle_f32 s[50:51], v52, v73
  v_cmp_nle_f32 s[52:53], v56, v73
  v_cmp_nle_f32 vcc, v60, v73
  v_mov_b32 v65, v64
  v_mov_b32 v67, v66
  v_mov_b32 v69, v68
  v_mov_b32 v71, v70
  s_or_b64 s[48:49], s[48:49], s[50:51]
  s_or_b64 vcc, vcc, s[52:53]
  s_or_b64 vcc, vcc, s[48:49]
  v_pk_mul_f32 v[128:129], v[128:129], v[64:65]
  v_pk_mul_f32 v[130:131], v[130:131], v[64:65]
  v_pk_mul_f32 v[144:145], v[144:145], v[64:65]
  v_pk_mul_f32 v[146:147], v[146:147], v[64:65]
  v_pk_mul_f32 v[132:133], v[132:133], v[66:67]
  v_pk_mul_f32 v[134:135], v[134:135], v[66:67]
  v_pk_mul_f32 v[148:149], v[148:149], v[66:67]
  v_pk_mul_f32 v[150:151], v[150:151], v[66:67]
  v_pk_mul_f32 v[136:137], v[136:137], v[68:69]
  v_pk_mul_f32 v[138:139], v[138:139], v[68:69]
  v_pk_mul_f32 v[152:153], v[152:153], v[68:69]
  v_pk_mul_f32 v[154:155], v[154:155], v[68:69]
  v_pk_mul_f32 v[140:141], v[140:141], v[70:71]
  v_pk_mul_f32 v[142:143], v[142:143], v[70:71]
  v_pk_mul_f32 v[156:157], v[156:157], v[70:71]
  v_pk_mul_f32 v[158:159], v[158:159], v[70:71]
  v_cvt_pk_bf16_f32 v112, v128, v129
  v_cvt_pk_bf16_f32 v113, v130, v131
  v_cvt_pk_bf16_f32 v114, v144, v145
  v_cvt_pk_bf16_f32 v115, v146, v147
  v_accvgpr_write_b32 a64, v112
  v_accvgpr_write_b32 a65, v113
  v_accvgpr_write_b32 a66, v114
  v_accvgpr_write_b32 a67, v115
  v_cvt_pk_bf16_f32 v116, v132, v133
  v_cvt_pk_bf16_f32 v117, v134, v135
  v_cvt_pk_bf16_f32 v118, v148, v149
  v_cvt_pk_bf16_f32 v119, v150, v151
  v_accvgpr_write_b32 a68, v116
  v_accvgpr_write_b32 a69, v117
  v_accvgpr_write_b32 a70, v118
  v_accvgpr_write_b32 a71, v119
  v_cvt_pk_bf16_f32 v120, v136, v137
  v_cvt_pk_bf16_f32 v121, v138, v139
  v_cvt_pk_bf16_f32 v122, v152, v153
  v_cvt_pk_bf16_f32 v123, v154, v155
  v_accvgpr_write_b32 a72, v120
  v_accvgpr_write_b32 a73, v121
  v_accvgpr_write_b32 a74, v122
  v_accvgpr_write_b32 a75, v123
  v_cvt_pk_bf16_f32 v124, v140, v141
  v_cvt_pk_bf16_f32 v125, v142, v143
  v_cvt_pk_bf16_f32 v126, v156, v157
  v_cvt_pk_bf16_f32 v127, v158, v159
  v_accvgpr_write_b32 a76, v124
  v_accvgpr_write_b32 a77, v125
  v_accvgpr_write_b32 a78, v126
  v_accvgpr_write_b32 a79, v127
  v_pk_mul_f32 v[160:161], v[160:161], v[64:65]
  v_pk_mul_f32 v[162:163], v[162:163], v[64:65]
  v_pk_mul_f32 v[176:177], v[176:177], v[64:65]
  v_pk_mul_f32 v[178:179], v[178:179], v[64:65]
  v_pk_mul_f32 v[164:165], v[164:165], v[66:67]
  v_pk_mul_f32 v[166:167], v[166:167], v[66:67]
  v_pk_mul_f32 v[180:181], v[180:181], v[66:67]
  v_pk_mul_f32 v[182:183], v[182:183], v[66:67]
  v_pk_mul_f32 v[168:169], v[168:169], v[68:69]
  v_pk_mul_f32 v[170:171], v[170:171], v[68:69]
  v_pk_mul_f32 v[184:185], v[184:185], v[68:69]
  v_pk_mul_f32 v[186:187], v[186:187], v[68:69]
  v_pk_mul_f32 v[172:173], v[172:173], v[70:71]
  v_pk_mul_f32 v[174:175], v[174:175], v[70:71]
  v_pk_mul_f32 v[188:189], v[188:189], v[70:71]
  v_pk_mul_f32 v[190:191], v[190:191], v[70:71]
  v_cvt_pk_bf16_f32 v112, v160, v161
  v_cvt_pk_bf16_f32 v113, v162, v163
  v_cvt_pk_bf16_f32 v114, v176, v177
  v_cvt_pk_bf16_f32 v115, v178, v179
  v_accvgpr_write_b32 a80, v112
  v_accvgpr_write_b32 a81, v113
  v_accvgpr_write_b32 a82, v114
  v_accvgpr_write_b32 a83, v115
  v_cvt_pk_bf16_f32 v116, v164, v165
  v_cvt_pk_bf16_f32 v117, v166, v167
  v_cvt_pk_bf16_f32 v118, v180, v181
  v_cvt_pk_bf16_f32 v119, v182, v183
  v_accvgpr_write_b32 a84, v116
  v_accvgpr_write_b32 a85, v117
  v_accvgpr_write_b32 a86, v118
  v_accvgpr_write_b32 a87, v119
  v_cvt_pk_bf16_f32 v120, v168, v169
  v_cvt_pk_bf16_f32 v121, v170, v171
  v_cvt_pk_bf16_f32 v122, v184, v185
  v_cvt_pk_bf16_f32 v123, v186, v187
  v_accvgpr_write_b32 a88, v120
  v_accvgpr_write_b32 a89, v121
  v_accvgpr_write_b32 a90, v122
  v_accvgpr_write_b32 a91, v123
  v_cvt_pk_bf16_f32 v124, v172, v173
  v_cvt_pk_bf16_f32 v125, v174, v175
  v_cvt_pk_bf16_f32 v126, v188, v189
  v_cvt_pk_bf16_f32 v127, v190, v191
  v_accvgpr_write_b32 a92, v124
  v_accvgpr_write_b32 a93, v125
  v_accvgpr_write_b32 a94, v126
  v_accvgpr_write_b32 a95, v127
  v_pk_mul_f32 v[192:193], v[192:193], v[64:65]
  v_pk_mul_f32 v[194:195], v[194:195], v[64:65]
  v_pk_mul_f32 v[208:209], v[208:209], v[64:65]
  v_pk_mul_f32 v[210:211], v[210:211], v[64:65]
  v_pk_mul_f32 v[196:197], v[196:197], v[66:67]
  v_pk_mul_f32 v[198:199], v[198:199], v[66:67]
  v_pk_mul_f32 v[212:213], v[212:213], v[66:67]
  v_pk_mul_f32 v[214:215], v[214:215], v[66:67]
  v_pk_mul_f32 v[200:201], v[200:201], v[68:69]
  v_pk_mul_f32 v[202:203], v[202:203], v[68:69]
  v_pk_mul_f32 v[216:217], v[216:217], v[68:69]
  v_pk_mul_f32 v[218:219], v[218:219], v[68:69]
  v_pk_mul_f32 v[204:205], v[204:205], v[70:71]
  v_pk_mul_f32 v[206:207], v[206:207], v[70:71]
  v_pk_mul_f32 v[220:221], v[220:221], v[70:71]
  v_pk_mul_f32 v[222:223], v[222:223], v[70:71]
  v_cvt_pk_bf16_f32 v112, v192, v193
  v_cvt_pk_bf16_f32 v113, v194, v195
  v_cvt_pk_bf16_f32 v114, v208, v209
  v_cvt_pk_bf16_f32 v115, v210, v211
  v_accvgpr_write_b32 a96, v112
  v_accvgpr_write_b32 a97, v113
  v_accvgpr_write_b32 a98, v114
  v_accvgpr_write_b32 a99, v115
  v_cvt_pk_bf16_f32 v116, v196, v197
  v_cvt_pk_bf16_f32 v117, v198, v199
  v_cvt_pk_bf16_f32 v118, v212, v213
  v_cvt_pk_bf16_f32 v119, v214, v215
  v_accvgpr_write_b32 a100, v116
  v_accvgpr_write_b32 a101, v117
  v_accvgpr_write_b32 a102, v118
  v_accvgpr_write_b32 a103, v119
  v_cvt_pk_bf16_f32 v120, v200, v201
  v_cvt_pk_bf16_f32 v121, v202, v203
  v_cvt_pk_bf16_f32 v122, v216, v217
  v_cvt_pk_bf16_f32 v123, v218, v219
  v_accvgpr_write_b32 a104, v120
  v_accvgpr_write_b32 a105, v121
  v_accvgpr_write_b32 a106, v122
  v_accvgpr_write_b32 a107, v123
  v_cvt_pk_bf16_f32 v124, v204, v205
  v_cvt_pk_bf16_f32 v125, v206, v207
  v_cvt_pk_bf16_f32 v126, v220, v221
  v_cvt_pk_bf16_f32 v127, v222, v223
  v_accvgpr_write_b32 a108, v124
  v_accvgpr_write_b32 a109, v125
  v_accvgpr_write_b32 a110, v126
  v_accvgpr_write_b32 a111, v127
  v_pk_mul_f32 v[224:225], v[224:225], v[64:65]
  v_pk_mul_f32 v[226:227], v[226:227], v[64:65]
  v_pk_mul_f32 v[240:241], v[240:241], v[64:65]
  v_pk_mul_f32 v[242:243], v[242:243], v[64:65]
  v_pk_mul_f32 v[228:229], v[228:229], v[66:67]
  v_pk_mul_f32 v[230:231], v[230:231], v[66:67]
  v_pk_mul_f32 v[244:245], v[244:245], v[66:67]
  v_pk_mul_f32 v[246:247], v[246:247], v[66:67]
  v_pk_mul_f32 v[232:233], v[232:233], v[68:69]
  v_pk_mul_f32 v[234:235], v[234:235], v[68:69]
  v_pk_mul_f32 v[248:249], v[248:249], v[68:69]
  v_pk_mul_f32 v[250:251], v[250:251], v[68:69]
  v_pk_mul_f32 v[236:237], v[236:237], v[70:71]
  v_pk_mul_f32 v[238:239], v[238:239], v[70:71]
  v_pk_mul_f32 v[252:253], v[252:253], v[70:71]
  v_pk_mul_f32 v[254:255], v[254:255], v[70:71]
  v_cvt_pk_bf16_f32 v112, v224, v225
  v_cvt_pk_bf16_f32 v113, v226, v227
  v_cvt_pk_bf16_f32 v114, v240, v241
  v_cvt_pk_bf16_f32 v115, v242, v243
  v_accvgpr_write_b32 a112, v112
  v_accvgpr_write_b32 a113, v113
  v_accvgpr_write_b32 a114, v114
  v_accvgpr_write_b32 a115, v115
  v_cvt_pk_bf16_f32 v116, v228, v229
  v_cvt_pk_bf16_f32 v117, v230, v231
  v_cvt_pk_bf16_f32 v118, v244, v245
  v_cvt_pk_bf16_f32 v119, v246, v247
  v_accvgpr_write_b32 a116, v116
  v_accvgpr_write_b32 a117, v117
  v_accvgpr_write_b32 a118, v118
  v_accvgpr_write_b32 a119, v119
  v_cvt_pk_bf16_f32 v120, v232, v233
  v_cvt_pk_bf16_f32 v121, v234, v235
  v_cvt_pk_bf16_f32 v122, v248, v249
  v_cvt_pk_bf16_f32 v123, v250, v251
  v_accvgpr_write_b32 a120, v120
  v_accvgpr_write_b32 a121, v121
  v_accvgpr_write_b32 a122, v122
  v_accvgpr_write_b32 a123, v123
  v_cvt_pk_bf16_f32 v124, v236, v237
  v_cvt_pk_bf16_f32 v125, v238, v239
  v_cvt_pk_bf16_f32 v126, v252, v253
  v_cvt_pk_bf16_f32 v127, v254, v255
  v_accvgpr_write_b32 a124, v124
  v_accvgpr_write_b32 a125, v125
  v_accvgpr_write_b32 a126, v126
  v_accvgpr_write_b32 a127, v127
  s_cbranch_vccz L_nobad1
  v_add_u32 v74, -256, v30
  v_mov_b32 v75, 1
  ds_write_b32 v74, v75
  s_waitcnt lgkmcnt(0)
L_nobad1:
  v_mov_b32 v84, 0
  v_mov_b32 v85, 0
  v_mov_b32 v86, 0
  v_mov_b32 v87, 0
  s_nop 1
  v_mfma_f32_32x32x16_bf16 v[128:143], v[84:87], v[84:87], 0
  v_mfma_f32_32x32x16_bf16 v[144:159], v[84:87], v[84:87], 0
  v_mfma_f32_32x32x16_bf16 v[160:175], v[84:87], v[84:87], 0
  v_mfma_f32_32x32x16_bf16 v[176:191], v[84:87], v[84:87], 0
  v_mfma_f32_32x32x16_bf16 v[192:207], v[84:87], v[84:87], 0
  v_mfma_f32_32x32x16_bf16 v[208:223], v[84:87], v[84:87], 0
  v_mfma_f32_32x32x16_bf16 v[224:239], v[84:87], v[84:87], 0
  v_mfma_f32_32x32x16_bf16 v[240:255], v[84:87], v[84:87], 0
  v_mfma_f32_32x32x16_bf16 v[48:63], v[84:87], v[84:87], 0
  s_branch L_switch_ret
L_endp:
  s_waitcnt vmcnt(0)
  s_cmp_eq_u32 s3, 0
  s_cbranch_scc1 L_f1_ok
  s_cmp_lg_u32 s24, 0
  s_cbranch_scc1 L_f1_ok
  v_and_b32 v24, v24, v25
  v_and_b32 v26, v26, v27
  v_and_b32 v24, v24, v26
  s_nop 0
  v_readfirstlane_b32 s48, v24
  s_bitcmp1_b32 s48, 2
  s_cbranch_scc1 L_f1_ok
L_f1_spin:
  s_sleep 16
  buffer_load_dwordx4 v[24:27], off, s[76:79], s92 sc1
  s_waitcnt vmcnt(0)
  v_and_b32 v24, v24, v25
  v_and_b32 v26, v26, v27
  v_and_b32 v24, v24, v26
  s_nop 0
  v_readfirstlane_b32 s48, v24
  s_bitcmp1_b32 s48, 2
  s_cbranch_scc0 L_f1_spin
L_f1_ok:
  s_barrier
  s_cmp_eq_u32 s3, 0
  s_cbranch_scc1 L_goslow
  v_mbcnt_lo_u32_b32 v20, -1, 0
  v_mbcnt_hi_u32_b32 v20, -1, v20
  v_and_b32 v21, 15, v20
  v_lshrrev_b32 v22, 4, v20
  v_lshrrev_b32 v23, 2, v21
  v_and_b32 v24, 3, v20
  v_lshl_add_u32 v26, v22, 2, v23
  v_lshrrev_b32 v27, 1, v26
  v_and_b32 v27, 3, v27
  v_lshlrev_b32 v26, 7, v26
  v_lshl_add_u32 v26, v24, 3, v26
  v_add_u32 v26, s91, v26
  v_xor_b32 v25, 0, v27
  v_lshl_add_u32 v96, v25, 5, v26
  v_xor_b32 v25, 1, v27
  v_lshl_add_u32 v97, v25, 5, v26
  v_xor_b32 v25, 2, v27
  v_lshl_add_u32 v98, v25, 5, v26
  v_xor_b32 v25, 3, v27
  v_lshl_add_u32 v99, v25, 5, v26
  v_lshlrev_b32 v25, 1, v22
  v_and_b32 v26, 7, v20
  v_xor_b32 v25, v25, v26
  v_lshlrev_b32 v25, 4, v25
  v_lshrrev_b32 v26, 3, v20
  v_lshl_add_u32 v25, v26, 10, v25
  v_add_u32 v100, 0, v25
  v_add_u32 v101, 7168, v25
  v_add_u32 v102, 14336, v25
  v_add_u32 v103, 21504, v25
  v_add_u32 v104, 0x1000, v1
  v_lshlrev_b32 v106, 10, v21
  v_lshl_add_u32 v106, v22, 3, v106
  s_lshl_b32 s88, s24, 5
  s_add_u32 s88, s88, 0
  s_lshl_b32 s89, s88, 15
  s_lshl_b32 s90, s88, 14
  s_add_u32 s90, s90, s93
  ds_read_b64_tr_b16 a[160:161], v6 offset:24576
  ds_read_b64_tr_b16 a[162:163], v6 offset:28672
  ds_read_b64_tr_b16 a[164:165], v7 offset:24576
  ds_read_b64_tr_b16 a[166:167], v7 offset:28672
  ds_read_b64_tr_b16 a[168:169], v8 offset:24576
  ds_read_b64_tr_b16 a[170:171], v8 offset:28672
  ds_read_b64_tr_b16 a[172:173], v9 offset:24576
  ds_read_b64_tr_b16 a[174:175], v9 offset:28672
  ds_read_b64_tr_b16 a[176:177], v10 offset:24576
  ds_read_b64_tr_b16 a[178:179], v10 offset:28672
  ds_read_b64_tr_b16 a[180:181], v11 offset:24576
  ds_read_b64_tr_b16 a[182:183], v11 offset:28672
  ds_read_b64_tr_b16 a[184:185], v12 offset:24576
  ds_read_b64_tr_b16 a[186:187], v12 offset:28672
  ds_read_b64_tr_b16 a[188:189], v13 offset:24576
  ds_read_b64_tr_b16 a[190:191], v13 offset:28672
  buffer_load_dwordx4 a[64:67], v1, s[20:23], s90 offen offset:0 sc1
  buffer_load_dwordx4 a[68:71], v1, s[20:23], s90 offen offset:1024 sc1
  buffer_load_dwordx4 a[72:75], v1, s[20:23], s90 offen offset:2048 sc1
  buffer_load_dwordx4 a[76:79], v1, s[20:23], s90 offen offset:3072 sc1
  buffer_load_dwordx4 a[80:83], v104, s[20:23], s90 offen offset:0 sc1
  buffer_load_dwordx4 a[84:87], v104, s[20:23], s90 offen offset:1024 sc1
  buffer_load_dwordx4 a[88:91], v104, s[20:23], s90 offen offset:2048 sc1
  buffer_load_dwordx4 a[92:95], v104, s[20:23], s90 offen offset:3072 sc1
  s_add_u32 m0, s91, 0x0
  s_nop 0
  buffer_load_dwordx4 v100, s[80:83], s89 offen offset:0 lds
  buffer_load_dwordx4 v101, s[80:83], s89 offen offset:1024 lds
  buffer_load_dwordx4 v102, s[80:83], s89 offen offset:2048 lds
  buffer_load_dwordx4 v103, s[80:83], s89 offen offset:3072 lds
  s_add_u32 s88, s88, 1
  s_lshl_b32 s89, s88, 15
  s_lshl_b32 s90, s88, 14
  s_add_u32 s90, s90, s93
  s_waitcnt lgkmcnt(0)
  v_mfma_f32_16x16x32_bf16 v[128:131], a[160:163], v[112:115], v[128:131]
  buffer_load_dwordx4 a[96:99], v1, s[20:23], s90 offen offset:0 sc1
  buffer_load_dwordx4 a[100:103], v1, s[20:23], s90 offen offset:1024 sc1
  v_mfma_f32_16x16x32_bf16 v[144:147], a[164:167], v[112:115], v[144:147]
  buffer_load_dwordx4 a[104:107], v1, s[20:23], s90 offen offset:2048 sc1
  buffer_load_dwordx4 a[108:111], v1, s[20:23], s90 offen offset:3072 sc1
  v_mfma_f32_16x16x32_bf16 v[160:163], a[168:171], v[112:115], v[160:163]
  buffer_load_dwordx4 a[112:115], v104, s[20:23], s90 offen offset:0 sc1
  buffer_load_dwordx4 a[116:119], v104, s[20:23], s90 offen offset:1024 sc1
  v_mfma_f32_16x16x32_bf16 v[176:179], a[172:175], v[112:115], v[176:179]
  buffer_load_dwordx4 a[120:123], v104, s[20:23], s90 offen offset:2048 sc1
  buffer_load_dwordx4 a[124:127], v104, s[20:23], s90 offen offset:3072 sc1
  v_mfma_f32_16x16x32_bf16 v[192:195], a[176:179], v[112:115], v[192:195]
  s_add_u32 m0, s91, 0x1000
  s_nop 0
  buffer_load_dwordx4 v100, s[80:83], s89 offen offset:0 lds
  buffer_load_dwordx4 v101, s[80:83], s89 offen offset:1024 lds
  v_mfma_f32_16x16x32_bf16 v[208:211], a[180:183], v[112:115], v[208:211]
  buffer_load_dwordx4 v102, s[80:83], s89 offen offset:2048 lds
  buffer_load_dwordx4 v103, s[80:83], s89 offen offset:3072 lds
  s_add_u32 s88, s88, 1
  s_lshl_b32 s89, s88, 15
  s_lshl_b32 s90, s88, 14
  s_add_u32 s90, s90, s93
  v_mfma_f32_16x16x32_bf16 v[224:227], a[184:187], v[112:115], v[224:227]
  v_mfma_f32_16x16x32_bf16 v[240:243], a[188:191], v[112:115], v[240:243]
  v_mfma_f32_16x16x32_bf16 v[48:51], a[192:195], v[112:115], v[48:51]
  v_mfma_f32_16x16x32_bf16 v[132:135], a[160:163], v[116:119], v[132:135]
  v_mfma_f32_16x16x32_bf16 v[148:151], a[164:167], v[116:119], v[148:151]
  v_mfma_f32_16x16x32_bf16 v[164:167], a[168:171], v[116:119], v[164:167]
  v_mfma_f32_16x16x32_bf16 v[180:183], a[172:175], v[116:119], v[180:183]
  v_mfma_f32_16x16x32_bf16 v[196:199], a[176:179], v[116:119], v[196:199]
  v_mfma_f32_16x16x32_bf16 v[212:215], a[180:183], v[116:119], v[212:215]
  v_mfma_f32_16x16x32_bf16 v[228:231], a[184:187], v[116:119], v[228:231]
  v_mfma_f32_16x16x32_bf16 v[244:247], a[188:191], v[116:119], v[244:247]
  v_mfma_f32_16x16x32_bf16 v[52:55], a[192:195], v[116:119], v[52:55]
  v_mfma_f32_16x16x32_bf16 v[136:139], a[160:163], v[120:123], v[136:139]
  v_mfma_f32_16x16x32_bf16 v[152:155], a[164:167], v[120:123], v[152:155]
  v_mfma_f32_16x16x32_bf16 v[168:171], a[168:171], v[120:123], v[168:171]
  v_mfma_f32_16x16x32_bf16 v[184:187], a[172:175], v[120:123], v[184:187]
  v_mfma_f32_16x16x32_bf16 v[200:203], a[176:179], v[120:123], v[200:203]
  v_mfma_f32_16x16x32_bf16 v[216:219], a[180:183], v[120:123], v[216:219]
  v_mfma_f32_16x16x32_bf16 v[232:235], a[184:187], v[120:123], v[232:235]
  v_mfma_f32_16x16x32_bf16 v[248:251], a[188:191], v[120:123], v[248:251]
  v_mfma_f32_16x16x32_bf16 v[56:59], a[192:195], v[120:123], v[56:59]
  v_mfma_f32_16x16x32_bf16 v[140:143], a[160:163], v[124:127], v[140:143]
  v_mfma_f32_16x16x32_bf16 v[156:159], a[164:167], v[124:127], v[156:159]
  v_mfma_f32_16x16x32_bf16 v[172:175], a[168:171], v[124:127], v[172:175]
  v_mfma_f32_16x16x32_bf16 v[188:191], a[172:175], v[124:127], v[188:191]
  v_mfma_f32_16x16x32_bf16 v[204:207], a[176:179], v[124:127], v[204:207]
  v_mfma_f32_16x16x32_bf16 v[220:223], a[180:183], v[124:127], v[220:223]
  v_mfma_f32_16x16x32_bf16 v[236:239], a[184:187], v[124:127], v[236:239]
  v_mfma_f32_16x16x32_bf16 v[252:255], a[188:191], v[124:127], v[252:255]
  v_mfma_f32_16x16x32_bf16 v[60:63], a[192:195], v[124:127], v[60:63]
  s_nop 7
  v_mov_b32 v73, 0x4e800000
  v_rcp_f32 v64, v48
  v_rcp_f32 v66, v52
  v_rcp_f32 v68, v56
  v_rcp_f32 v70, v60
  v_cmp_nle_f32 s[48:49], v48, v73
  v_cmp_nle_f32 s[50:51], v52, v73
  v_cmp_nle_f32 s[52:53], v56, v73
  v_cmp_nle_f32 vcc, v60, v73
  v_mov_b32 v65, v64
  v_mov_b32 v67, v66
  v_mov_b32 v69, v68
  v_mov_b32 v71, v70
  s_or_b64 s[48:49], s[48:49], s[50:51]
  s_or_b64 vcc, vcc, s[52:53]
  s_or_b64 vcc, vcc, s[48:49]
  v_pk_mul_f32 v[128:129], v[128:129], v[64:65]
  v_pk_mul_f32 v[130:131], v[130:131], v[64:65]
  v_pk_mul_f32 v[144:145], v[144:145], v[64:65]
  v_pk_mul_f32 v[146:147], v[146:147], v[64:65]
  v_pk_mul_f32 v[132:133], v[132:133], v[66:67]
  v_pk_mul_f32 v[134:135], v[134:135], v[66:67]
  v_pk_mul_f32 v[148:149], v[148:149], v[66:67]
  v_pk_mul_f32 v[150:151], v[150:151], v[66:67]
  v_pk_mul_f32 v[136:137], v[136:137], v[68:69]
  v_pk_mul_f32 v[138:139], v[138:139], v[68:69]
  v_pk_mul_f32 v[152:153], v[152:153], v[68:69]
  v_pk_mul_f32 v[154:155], v[154:155], v[68:69]
  v_pk_mul_f32 v[140:141], v[140:141], v[70:71]
  v_pk_mul_f32 v[142:143], v[142:143], v[70:71]
  v_pk_mul_f32 v[156:157], v[156:157], v[70:71]
  v_pk_mul_f32 v[158:159], v[158:159], v[70:71]
  v_cvt_pk_bf16_f32 v32, v128, v129
  v_cvt_pk_bf16_f32 v33, v130, v131
  v_cvt_pk_bf16_f32 v34, v144, v145
  v_cvt_pk_bf16_f32 v35, v146, v147
  v_cvt_pk_bf16_f32 v36, v132, v133
  v_cvt_pk_bf16_f32 v37, v134, v135
  v_cvt_pk_bf16_f32 v38, v148, v149
  v_cvt_pk_bf16_f32 v39, v150, v151
  v_cvt_pk_bf16_f32 v40, v136, v137
  v_cvt_pk_bf16_f32 v41, v138, v139
  v_cvt_pk_bf16_f32 v42, v152, v153
  v_cvt_pk_bf16_f32 v43, v154, v155
  v_cvt_pk_bf16_f32 v44, v140, v141
  v_cvt_pk_bf16_f32 v45, v142, v143
  v_cvt_pk_bf16_f32 v46, v156, v157
  v_cvt_pk_bf16_f32 v47, v158, v159
  s_nop 1
  buffer_store_dwordx4 v[32:35], v1, s[20:23], s31 offen offset:0 sc1
  buffer_store_dwordx4 v[36:39], v1, s[20:23], s31 offen offset:1024 sc1
  buffer_store_dwordx4 v[40:43], v1, s[20:23], s31 offen offset:2048 sc1
  buffer_store_dwordx4 v[44:47], v1, s[20:23], s31 offen offset:3072 sc1
  s_add_u32 s31, s31, 0x4000
  v_pk_mul_f32 v[160:161], v[160:161], v[64:65]
  v_pk_mul_f32 v[162:163], v[162:163], v[64:65]
  v_pk_mul_f32 v[176:177], v[176:177], v[64:65]
  v_pk_mul_f32 v[178:179], v[178:179], v[64:65]
  v_pk_mul_f32 v[164:165], v[164:165], v[66:67]
  v_pk_mul_f32 v[166:167], v[166:167], v[66:67]
  v_pk_mul_f32 v[180:181], v[180:181], v[66:67]
  v_pk_mul_f32 v[182:183], v[182:183], v[66:67]
  v_pk_mul_f32 v[168:169], v[168:169], v[68:69]
  v_pk_mul_f32 v[170:171], v[170:171], v[68:69]
  v_pk_mul_f32 v[184:185], v[184:185], v[68:69]
  v_pk_mul_f32 v[186:187], v[186:187], v[68:69]
  v_pk_mul_f32 v[172:173], v[172:173], v[70:71]
  v_pk_mul_f32 v[174:175], v[174:175], v[70:71]
  v_pk_mul_f32 v[188:189], v[188:189], v[70:71]
  v_pk_mul_f32 v[190:191], v[190:191], v[70:71]
  v_cvt_pk_bf16_f32 v48, v160, v161
  v_cvt_pk_bf16_f32 v49, v162, v163
  v_cvt_pk_bf16_f32 v50, v176, v177
  v_cvt_pk_bf16_f32 v51, v178, v179
  v_cvt_pk_bf16_f32 v52, v164, v165
  v_cvt_pk_bf16_f32 v53, v166, v167
  v_cvt_pk_bf16_f32 v54, v180, v181
  v_cvt_pk_bf16_f32 v55, v182, v183
  v_cvt_pk_bf16_f32 v56, v168, v169
  v_cvt_pk_bf16_f32 v57, v170, v171
  v_cvt_pk_bf16_f32 v58, v184, v185
  v_cvt_pk_bf16_f32 v59, v186, v187
  v_cvt_pk_bf16_f32 v60, v172, v173
  v_cvt_pk_bf16_f32 v61, v174, v175
  v_cvt_pk_bf16_f32 v62, v188, v189
  v_cvt_pk_bf16_f32 v63, v190, v191
  s_nop 1
  buffer_store_dwordx4 v[48:51], v1, s[20:23], s31 offen offset:0 sc1
  buffer_store_dwordx4 v[52:55], v1, s[20:23], s31 offen offset:1024 sc1
  buffer_store_dwordx4 v[56:59], v1, s[20:23], s31 offen offset:2048 sc1
  buffer_store_dwordx4 v[60:63], v1, s[20:23], s31 offen offset:3072 sc1
  s_add_u32 s31, s31, 0x4000
  v_pk_mul_f32 v[192:193], v[192:193], v[64:65]
  v_pk_mul_f32 v[194:195], v[194:195], v[64:65]
  v_pk_mul_f32 v[208:209], v[208:209], v[64:65]
  v_pk_mul_f32 v[210:211], v[210:211], v[64:65]
  v_pk_mul_f32 v[196:197], v[196:197], v[66:67]
  v_pk_mul_f32 v[198:199], v[198:199], v[66:67]
  v_pk_mul_f32 v[212:213], v[212:213], v[66:67]
  v_pk_mul_f32 v[214:215], v[214:215], v[66:67]
  v_pk_mul_f32 v[200:201], v[200:201], v[68:69]
  v_pk_mul_f32 v[202:203], v[202:203], v[68:69]
  v_pk_mul_f32 v[216:217], v[216:217], v[68:69]
  v_pk_mul_f32 v[218:219], v[218:219], v[68:69]
  v_pk_mul_f32 v[204:205], v[204:205], v[70:71]
  v_pk_mul_f32 v[206:207], v[206:207], v[70:71]
  v_pk_mul_f32 v[220:221], v[220:221], v[70:71]
  v_pk_mul_f32 v[222:223], v[222:223], v[70:71]
  v_cvt_pk_bf16_f32 v112, v192, v193
  v_cvt_pk_bf16_f32 v113, v194, v195
  v_cvt_pk_bf16_f32 v114, v208, v209
  v_cvt_pk_bf16_f32 v115, v210, v211
  v_cvt_pk_bf16_f32 v116, v196, v197
  v_cvt_pk_bf16_f32 v117, v198, v199
  v_cvt_pk_bf16_f32 v118, v212, v213
  v_cvt_pk_bf16_f32 v119, v214, v215
  v_cvt_pk_bf16_f32 v120, v200, v201
  v_cvt_pk_bf16_f32 v121, v202, v203
  v_cvt_pk_bf16_f32 v122, v216, v217
  v_cvt_pk_bf16_f32 v123, v218, v219
  v_cvt_pk_bf16_f32 v124, v204, v205
  v_cvt_pk_bf16_f32 v125, v206, v207
  v_cvt_pk_bf16_f32 v126, v220, v221
  v_cvt_pk_bf16_f32 v127, v222, v223
  s_nop 1
  buffer_store_dwordx4 v[112:115], v1, s[20:23], s31 offen offset:0 sc1
  buffer_store_dwordx4 v[116:119], v1, s[20:23], s31 offen offset:1024 sc1
  buffer_store_dwordx4 v[120:123], v1, s[20:23], s31 offen offset:2048 sc1
  buffer_store_dwordx4 v[124:127], v1, s[20:23], s31 offen offset:3072 sc1
  s_add_u32 s31, s31, 0x4000
  v_pk_mul_f32 v[224:225], v[224:225], v[64:65]
  v_pk_mul_f32 v[226:227], v[226:227], v[64:65]
  v_pk_mul_f32 v[240:241], v[240:241], v[64:65]
  v_pk_mul_f32 v[242:243], v[242:243], v[64:65]
  v_pk_mul_f32 v[228:229], v[228:229], v[66:67]
  v_pk_mul_f32 v[230:231], v[230:231], v[66:67]
  v_pk_mul_f32 v[244:245], v[244:245], v[66:67]
  v_pk_mul_f32 v[246:247], v[246:247], v[66:67]
  v_pk_mul_f32 v[232:233], v[232:233], v[68:69]
  v_pk_mul_f32 v[234:235], v[234:235], v[68:69]
  v_pk_mul_f32 v[248:249], v[248:249], v[68:69]
  v_pk_mul_f32 v[250:251], v[250:251], v[68:69]
  v_pk_mul_f32 v[236:237], v[236:237], v[70:71]
  v_pk_mul_f32 v[238:239], v[238:239], v[70:71]
  v_pk_mul_f32 v[252:253], v[252:253], v[70:71]
  v_pk_mul_f32 v[254:255], v[254:255], v[70:71]
  v_cvt_pk_bf16_f32 v2, v224, v225
  v_cvt_pk_bf16_f32 v3, v226, v227
  v_cvt_pk_bf16_f32 v4, v240, v241
  v_cvt_pk_bf16_f32 v5, v242, v243
  v_cvt_pk_bf16_f32 v6, v228, v229
  v_cvt_pk_bf16_f32 v7, v230, v231
  v_cvt_pk_bf16_f32 v8, v244, v245
  v_cvt_pk_bf16_f32 v9, v246, v247
  v_cvt_pk_bf16_f32 v10, v232, v233
  v_cvt_pk_bf16_f32 v11, v234, v235
  v_cvt_pk_bf16_f32 v12, v248, v249
  v_cvt_pk_bf16_f32 v13, v250, v251
  v_cvt_pk_bf16_f32 v14, v236, v237
  v_cvt_pk_bf16_f32 v15, v238, v239
  v_cvt_pk_bf16_f32 v16, v252, v253
  v_cvt_pk_bf16_f32 v17, v254, v255
  s_nop 1
  buffer_store_dwordx4 v[2:5], v1, s[20:23], s31 offen offset:0 sc1
  buffer_store_dwordx4 v[6:9], v1, s[20:23], s31 offen offset:1024 sc1
  buffer_store_dwordx4 v[10:13], v1, s[20:23], s31 offen offset:2048 sc1
  buffer_store_dwordx4 v[14:17], v1, s[20:23], s31 offen offset:3072 sc1
  s_add_u32 s31, s31, 0x4000
  s_cmp_lg_u64 vcc, 0
  s_cselect_b32 s48, 1, 0
  s_lshl_b32 s49, s24, 2
  s_add_u32 s49, s49, 0x19000
  v_mov_b32 v110, s49
  v_mov_b32 v111, s48
  ds_write_b32 v110, v111
  buffer_load_dwordx4 a[0:3], v1, s[20:23], s90 offen offset:0 sc1
  buffer_load_dwordx4 a[4:7], v1, s[20:23], s90 offen offset:1024 sc1
  buffer_load_dwordx4 a[8:11], v1, s[20:23], s90 offen offset:2048 sc1
  buffer_load_dwordx4 a[12:15], v1, s[20:23], s90 offen offset:3072 sc1
  buffer_load_dwordx4 a[16:19], v104, s[20:23], s90 offen offset:0 sc1
  buffer_load_dwordx4 a[20:23], v104, s[20:23], s90 offen offset:1024 sc1
  buffer_load_dwordx4 a[24:27], v104, s[20:23], s90 offen offset:2048 sc1
  buffer_load_dwordx4 a[28:31], v104, s[20:23], s90 offen offset:3072 sc1
  s_add_u32 m0, s91, 0x2000
  s_nop 0
  buffer_load_dwordx4 v100, s[80:83], s89 offen offset:0 lds
  buffer_load_dwordx4 v101, s[80:83], s89 offen offset:1024 lds
  buffer_load_dwordx4 v102, s[80:83], s89 offen offset:2048 lds
  buffer_load_dwordx4 v103, s[80:83], s89 offen offset:3072 lds
  s_add_u32 s88, s88, 1
  s_lshl_b32 s89, s88, 15
  s_lshl_b32 s90, s88, 14
  s_add_u32 s90, s90, s93
  buffer_load_dwordx4 a[32:35], v1, s[20:23], s90 offen offset:0 sc1
  buffer_load_dwordx4 a[36:39], v1, s[20:23], s90 offen offset:1024 sc1
  buffer_load_dwordx4 a[40:43], v1, s[20:23], s90 offen offset:2048 sc1
  buffer_load_dwordx4 a[44:47], v1, s[20:23], s90 offen offset:3072 sc1
  buffer_load_dwordx4 a[48:51], v104, s[20:23], s90 offen offset:0 sc1
  buffer_load_dwordx4 a[52:55], v104, s[20:23], s90 offen offset:1024 sc1
  buffer_load_dwordx4 a[56:59], v104, s[20:23], s90 offen offset:2048 sc1
  buffer_load_dwordx4 a[60:63], v104, s[20:23], s90 offen offset:3072 sc1
  s_add_u32 m0, s91, 0x3000
  s_nop 0
  buffer_load_dwordx4 v100, s[80:83], s89 offen offset:0 lds
  buffer_load_dwordx4 v101, s[80:83], s89 offen offset:1024 lds
  buffer_load_dwordx4 v102, s[80:83], s89 offen offset:2048 lds
  buffer_load_dwordx4 v103, s[80:83], s89 offen offset:3072 lds
  s_add_u32 s88, s88, 5
  s_lshl_b32 s89, s88, 15
  s_lshl_b32 s90, s88, 14
  s_add_u32 s90, s90, s93
  buffer_load_dwordx4 a[128:131], v1, s[20:23], s90 offen offset:0 sc1
  buffer_load_dwordx4 a[132:135], v1, s[20:23], s90 offen offset:1024 sc1
  buffer_load_dwordx4 a[136:139], v1, s[20:23], s90 offen offset:2048 sc1
  buffer_load_dwordx4 a[140:143], v1, s[20:23], s90 offen offset:3072 sc1
  buffer_load_dwordx4 a[144:147], v104, s[20:23], s90 offen offset:0 sc1
  buffer_load_dwordx4 a[148:151], v104, s[20:23], s90 offen offset:1024 sc1
  buffer_load_dwordx4 a[152:155], v104, s[20:23], s90 offen offset:2048 sc1
  buffer_load_dwordx4 a[156:159], v104, s[20:23], s90 offen offset:3072 sc1
  s_add_u32 m0, s91, 0x4000
  s_nop 0
  buffer_load_dwordx4 v100, s[80:83], s89 offen offset:0 lds
  buffer_load_dwordx4 v101, s[80:83], s89 offen offset:1024 lds
  buffer_load_dwordx4 v102, s[80:83], s89 offen offset:2048 lds
  buffer_load_dwordx4 v103, s[80:83], s89 offen offset:3072 lds
  s_add_u32 s88, s88, 1
  s_lshl_b32 s89, s88, 15
  s_lshl_b32 s90, s88, 14
  s_add_u32 s90, s90, s93
  v_mov_b32 v84, 0
  v_mov_b32 v85, 0
  v_mov_b32 v86, 0
  v_mov_b32 v87, 0
L_oproj:
  s_nop 1
  v_mfma_f32_32x32x16_bf16 v[128:143], v[84:87], v[84:87], 0
  v_mfma_f32_32x32x16_bf16 v[144:159], v[84:87], v[84:87], 0
  v_mfma_f32_32x32x16_bf16 v[160:175], v[84:87], v[84:87], 0
  v_mfma_f32_32x32x16_bf16 v[176:191], v[84:87], v[84:87], 0
  v_mfma_f32_32x32x16_bf16 v[192:207], v[84:87], v[84:87], 0
  v_mfma_f32_32x32x16_bf16 v[208:223], v[84:87], v[84:87], 0
  v_mfma_f32_32x32x16_bf16 v[224:239], v[84:87], v[84:87], 0
  v_mfma_f32_32x32x16_bf16 v[240:255], v[84:87], v[84:87], 0
  s_waitcnt vmcnt(52)
  ds_read_b64_tr_b16 v[64:65], v96 offset:0
  ds_read_b64_tr_b16 v[66:67], v96 offset:2048
  ds_read_b64_tr_b16 v[68:69], v97 offset:0
  ds_read_b64_tr_b16 v[70:71], v97 offset:2048
  ds_read_b64_tr_b16 v[72:73], v98 offset:0
  ds_read_b64_tr_b16 v[74:75], v98 offset:2048
  ds_read_b64_tr_b16 v[76:77], v99 offset:0
  ds_read_b64_tr_b16 v[78:79], v99 offset:2048
  s_waitcnt lgkmcnt(0)
  s_mov_b32 s30, 0
  s_branch L_ostep0
L_oloop:
  s_waitcnt vmcnt(36)
L_ostep0:
  v_mfma_f32_16x16x32_bf16 v[128:131], v[64:67], a[64:67], v[128:131]
  v_mfma_f32_16x16x32_bf16 v[132:135], v[64:67], a[68:71], v[132:135]
  ds_read_b64_tr_b16 v[80:81], v96 offset:4096
  v_mfma_f32_16x16x32_bf16 v[136:139], v[64:67], a[72:75], v[136:139]
  buffer_load_dwordx4 a[160:163], v1, s[20:23], s90 offen offset:0 sc1
  v_mfma_f32_16x16x32_bf16 v[140:143], v[64:67], a[76:79], v[140:143]
  buffer_load_dwordx4 a[164:167], v1, s[20:23], s90 offen offset:1024 sc1
  v_mfma_f32_16x16x32_bf16 v[144:147], v[64:67], a[80:83], v[144:147]
  ds_read_b64_tr_b16 v[82:83], v96 offset:6144
  v_mfma_f32_16x16x32_bf16 v[148:151], v[64:67], a[84:87], v[148:151]
  v_mfma_f32_16x16x32_bf16 v[152:155], v[64:67], a[88:91], v[152:155]
  buffer_load_dwordx4 a[168:171], v1, s[20:23], s90 offen offset:2048 sc1
  v_mfma_f32_16x16x32_bf16 v[156:159], v[64:67], a[92:95], v[156:159]
  ds_read_b64_tr_b16 v[84:85], v97 offset:4096
  v_mfma_f32_16x16x32_bf16 v[160:163], v[68:71], a[64:67], v[160:163]
  v_mfma_f32_16x16x32_bf16 v[164:167], v[68:71], a[68:71], v[164:167]
  buffer_load_dwordx4 a[172:175], v1, s[20:23], s90 offen offset:3072 sc1
  v_mfma_f32_16x16x32_bf16 v[168:171], v[68:71], a[72:75], v[168:171]
  ds_read_b64_tr_b16 v[86:87], v97 offset:6144
  v_mfma_f32_16x16x32_bf16 v[172:175], v[68:71], a[76:79], v[172:175]
  buffer_load_dwordx4 a[176:179], v104, s[20:23], s90 offen offset:0 sc1
  v_mfma_f32_16x16x32_bf16 v[176:179], v[68:71], a[80:83], v[176:179]
  v_mfma_f32_16x16x32_bf16 v[180:183], v[68:71], a[84:87], v[180:183]
  ds_read_b64_tr_b16 v[88:89], v98 offset:4096
  v_mfma_f32_16x16x32_bf16 v[184:187], v[68:71], a[88:91], v[184:187]
  buffer_load_dwordx4 a[180:183], v104, s[20:23], s90 offen offset:1024 sc1
  v_mfma_f32_16x16x32_bf16 v[188:191], v[68:71], a[92:95], v[188:191]
  v_mfma_f32_16x16x32_bf16 v[192:195], v[72:75], a[64:67], v[192:195]
  ds_read_b64_tr_b16 v[90:91], v98 offset:6144
  v_mfma_f32_16x16x32_bf16 v[196:199], v[72:75], a[68:71], v[196:199]
  buffer_load_dwordx4 a[184:187], v104, s[20:23], s90 offen offset:2048 sc1
  v_mfma_f32_16x16x32_bf16 v[200:203], v[72:75], a[72:75], v[200:203]
  buffer_load_dwordx4 a[188:191], v104, s[20:23], s90 offen offset:3072 sc1
  v_mfma_f32_16x16x32_bf16 v[204:207], v[72:75], a[76:79], v[204:207]
  ds_read_b64_tr_b16 v[92:93], v99 offset:4096
  v_mfma_f32_16x16x32_bf16 v[208:211], v[72:75], a[80:83], v[208:211]
  s_add_u32 m0, s91, 0x5000
  v_mfma_f32_16x16x32_bf16 v[212:215], v[72:75], a[84:87], v[212:215]
  buffer_load_dwordx4 v100, s[80:83], s89 offen offset:0 lds
  v_mfma_f32_16x16x32_bf16 v[216:219], v[72:75], a[88:91], v[216:219]
  ds_read_b64_tr_b16 v[94:95], v99 offset:6144
  v_mfma_f32_16x16x32_bf16 v[220:223], v[72:75], a[92:95], v[220:223]
  v_mfma_f32_16x16x32_bf16 v[224:227], v[76:79], a[64:67], v[224:227]
  buffer_load_dwordx4 v101, s[80:83], s89 offen offset:1024 lds
  v_mfma_f32_16x16x32_bf16 v[228:231], v[76:79], a[68:71], v[228:231]
  buffer_load_dwordx4 v102, s[80:83], s89 offen offset:2048 lds
  v_mfma_f32_16x16x32_bf16 v[232:235], v[76:79], a[72:75], v[232:235]
  v_mfma_f32_16x16x32_bf16 v[236:239], v[76:79], a[76:79], v[236:239]
  buffer_load_dwordx4 v103, s[80:83], s89 offen offset:3072 lds
  v_mfma_f32_16x16x32_bf16 v[240:243], v[76:79], a[80:83], v[240:243]
  s_add_u32 s88, s88, 1
  s_lshl_b32 s89, s88, 15
  s_lshl_b32 s90, s88, 14
  v_mfma_f32_16x16x32_bf16 v[244:247], v[76:79], a[84:87], v[244:247]
  s_add_u32 s90, s90, s93
  v_mfma_f32_16x16x32_bf16 v[248:251], v[76:79], a[88:91], v[248:251]
  v_mfma_f32_16x16x32_bf16 v[252:255], v[76:79], a[92:95], v[252:255]
  s_waitcnt lgkmcnt(0)
  s_waitcnt vmcnt(36)
  v_mfma_f32_16x16x32_bf16 v[128:131], v[80:83], a[96:99], v[128:131]
  v_mfma_f32_16x16x32_bf16 v[132:135], v[80:83], a[100:103], v[132:135]
  ds_read_b64_tr_b16 v[64:65], v96 offset:8192
  v_mfma_f32_16x16x32_bf16 v[136:139], v[80:83], a[104:107], v[136:139]
  buffer_load_dwordx4 a[192:195], v1, s[20:23], s90 offen offset:0 sc1
  v_mfma_f32_16x16x32_bf16 v[140:143], v[80:83], a[108:111], v[140:143]
  buffer_load_dwordx4 a[196:199], v1, s[20:23], s90 offen offset:1024 sc1
  v_mfma_f32_16x16x32_bf16 v[144:147], v[80:83], a[112:115], v[144:147]
  ds_read_b64_tr_b16 v[66:67], v96 offset:10240
  v_mfma_f32_16x16x32_bf16 v[148:151], v[80:83], a[116:119], v[148:151]
  v_mfma_f32_16x16x32_bf16 v[152:155], v[80:83], a[120:123], v[152:155]
  buffer_load_dwordx4 a[200:203], v1, s[20:23], s90 offen offset:2048 sc1
  v_mfma_f32_16x16x32_bf16 v[156:159], v[80:83], a[124:127], v[156:159]
  ds_read_b64_tr_b16 v[68:69], v97 offset:8192
  v_mfma_f32_16x16x32_bf16 v[160:163], v[84:87], a[96:99], v[160:163]
  v_mfma_f32_16x16x32_bf16 v[164:167], v[84:87], a[100:103], v[164:167]
  buffer_load_dwordx4 a[204:207], v1, s[20:23], s90 offen offset:3072 sc1
  v_mfma_f32_16x16x32_bf16 v[168:171], v[84:87], a[104:107], v[168:171]
  ds_read_b64_tr_b16 v[70:71], v97 offset:10240
  v_mfma_f32_16x16x32_bf16 v[172:175], v[84:87], a[108:111], v[172:175]
  buffer_load_dwordx4 a[208:211], v104, s[20:23], s90 offen offset:0 sc1
  v_mfma_f32_16x16x32_bf16 v[176:179], v[84:87], a[112:115], v[176:179]
  v_mfma_f32_16x16x32_bf16 v[180:183], v[84:87], a[116:119], v[180:183]
  ds_read_b64_tr_b16 v[72:73], v98 offset:8192
  v_mfma_f32_16x16x32_bf16 v[184:187], v[84:87], a[120:123], v[184:187]
  buffer_load_dwordx4 a[212:215], v104, s[20:23], s90 offen offset:1024 sc1
  v_mfma_f32_16x16x32_bf16 v[188:191], v[84:87], a[124:127], v[188:191]
  v_mfma_f32_16x16x32_bf16 v[192:195], v[88:91], a[96:99], v[192:195]
  ds_read_b64_tr_b16 v[74:75], v98 offset:10240
  v_mfma_f32_16x16x32_bf16 v[196:199], v[88:91], a[100:103], v[196:199]
  buffer_load_dwordx4 a[216:219], v104, s[20:23], s90 offen offset:2048 sc1
  v_mfma_f32_16x16x32_bf16 v[200:203], v[88:91], a[104:107], v[200:203]
  buffer_load_dwordx4 a[220:223], v104, s[20:23], s90 offen offset:3072 sc1
  v_mfma_f32_16x16x32_bf16 v[204:207], v[88:91], a[108:111], v[204:207]
  ds_read_b64_tr_b16 v[76:77], v99 offset:8192
  v_mfma_f32_16x16x32_bf16 v[208:211], v[88:91], a[112:115], v[208:211]
  s_add_u32 m0, s91, 0x6000
  v_mfma_f32_16x16x32_bf16 v[212:215], v[88:91], a[116:119], v[212:215]
  buffer_load_dwordx4 v100, s[80:83], s89 offen offset:0 lds
  v_mfma_f32_16x16x32_bf16 v[216:219], v[88:91], a[120:123], v[216:219]
  ds_read_b64_tr_b16 v[78:79], v99 offset:10240
  v_mfma_f32_16x16x32_bf16 v[220:223], v[88:91], a[124:127], v[220:223]
  v_mfma_f32_16x16x32_bf16 v[224:227], v[92:95], a[96:99], v[224:227]
  buffer_load_dwordx4 v101, s[80:83], s89 offen offset:1024 lds
  v_mfma_f32_16x16x32_bf16 v[228:231], v[92:95], a[100:103], v[228:231]
  buffer_load_dwordx4 v102, s[80:83], s89 offen offset:2048 lds
  v_mfma_f32_16x16x32_bf16 v[232:235], v[92:95], a[104:107], v[232:235]
  v_mfma_f32_16x16x32_bf16 v[236:239], v[92:95], a[108:111], v[236:239]
  buffer_load_dwordx4 v103, s[80:83], s89 offen offset:3072 lds
  v_mfma_f32_16x16x32_bf16 v[240:243], v[92:95], a[112:115], v[240:243]
  s_add_u32 s88, s88, 1
  s_lshl_b32 s89, s88, 15
  s_lshl_b32 s90, s88, 14
  v_mfma_f32_16x16x32_bf16 v[244:247], v[92:95], a[116:119], v[244:247]
  s_add_u32 s90, s90, s93
  v_mfma_f32_16x16x32_bf16 v[248:251], v[92:95], a[120:123], v[248:251]
  v_mfma_f32_16x16x32_bf16 v[252:255], v[92:95], a[124:127], v[252:255]
  s_waitcnt lgkmcnt(0)
  s_waitcnt vmcnt(36)
  v_mfma_f32_16x16x32_bf16 v[128:131], v[64:67], a[0:3], v[128:131]
  v_mfma_f32_16x16x32_bf16 v[132:135], v[64:67], a[4:7], v[132:135]
  ds_read_b64_tr_b16 v[80:81], v96 offset:12288
  v_mfma_f32_16x16x32_bf16 v[136:139], v[64:67], a[8:11], v[136:139]
  buffer_load_dwordx4 a[224:227], v1, s[20:23], s90 offen offset:0 sc1
  v_mfma_f32_16x16x32_bf16 v[140:143], v[64:67], a[12:15], v[140:143]
  buffer_load_dwordx4 a[228:231], v1, s[20:23], s90 offen offset:1024 sc1
  v_mfma_f32_16x16x32_bf16 v[144:147], v[64:67], a[16:19], v[144:147]
  ds_read_b64_tr_b16 v[82:83], v96 offset:14336
  v_mfma_f32_16x16x32_bf16 v[148:151], v[64:67], a[20:23], v[148:151]
  v_mfma_f32_16x16x32_bf16 v[152:155], v[64:67], a[24:27], v[152:155]
  buffer_load_dwordx4 a[232:235], v1, s[20:23], s90 offen offset:2048 sc1
  v_mfma_f32_16x16x32_bf16 v[156:159], v[64:67], a[28:31], v[156:159]
  ds_read_b64_tr_b16 v[84:85], v97 offset:12288
  v_mfma_f32_16x16x32_bf16 v[160:163], v[68:71], a[0:3], v[160:163]
  v_mfma_f32_16x16x32_bf16 v[164:167], v[68:71], a[4:7], v[164:167]
  buffer_load_dwordx4 a[236:239], v1, s[20:23], s90 offen offset:3072 sc1
  v_mfma_f32_16x16x32_bf16 v[168:171], v[68:71], a[8:11], v[168:171]
  ds_read_b64_tr_b16 v[86:87], v97 offset:14336
  v_mfma_f32_16x16x32_bf16 v[172:175], v[68:71], a[12:15], v[172:175]
  buffer_load_dwordx4 a[240:243], v104, s[20:23], s90 offen offset:0 sc1
  v_mfma_f32_16x16x32_bf16 v[176:179], v[68:71], a[16:19], v[176:179]
  v_mfma_f32_16x16x32_bf16 v[180:183], v[68:71], a[20:23], v[180:183]
  ds_read_b64_tr_b16 v[88:89], v98 offset:12288
  v_mfma_f32_16x16x32_bf16 v[184:187], v[68:71], a[24:27], v[184:187]
  buffer_load_dwordx4 a[244:247], v104, s[20:23], s90 offen offset:1024 sc1
  v_mfma_f32_16x16x32_bf16 v[188:191], v[68:71], a[28:31], v[188:191]
  v_mfma_f32_16x16x32_bf16 v[192:195], v[72:75], a[0:3], v[192:195]
  ds_read_b64_tr_b16 v[90:91], v98 offset:14336
  v_mfma_f32_16x16x32_bf16 v[196:199], v[72:75], a[4:7], v[196:199]
  buffer_load_dwordx4 a[248:251], v104, s[20:23], s90 offen offset:2048 sc1
  v_mfma_f32_16x16x32_bf16 v[200:203], v[72:75], a[8:11], v[200:203]
  buffer_load_dwordx4 a[252:255], v104, s[20:23], s90 offen offset:3072 sc1
  v_mfma_f32_16x16x32_bf16 v[204:207], v[72:75], a[12:15], v[204:207]
  ds_read_b64_tr_b16 v[92:93], v99 offset:12288
  v_mfma_f32_16x16x32_bf16 v[208:211], v[72:75], a[16:19], v[208:211]
  s_add_u32 m0, s91, 0x7000
  v_mfma_f32_16x16x32_bf16 v[212:215], v[72:75], a[20:23], v[212:215]
  buffer_load_dwordx4 v100, s[80:83], s89 offen offset:0 lds
  v_mfma_f32_16x16x32_bf16 v[216:219], v[72:75], a[24:27], v[216:219]
  ds_read_b64_tr_b16 v[94:95], v99 offset:14336
  v_mfma_f32_16x16x32_bf16 v[220:223], v[72:75], a[28:31], v[220:223]
  v_mfma_f32_16x16x32_bf16 v[224:227], v[76:79], a[0:3], v[224:227]
  buffer_load_dwordx4 v101, s[80:83], s89 offen offset:1024 lds
  v_mfma_f32_16x16x32_bf16 v[228:231], v[76:79], a[4:7], v[228:231]
  buffer_load_dwordx4 v102, s[80:83], s89 offen offset:2048 lds
  v_mfma_f32_16x16x32_bf16 v[232:235], v[76:79], a[8:11], v[232:235]
  v_mfma_f32_16x16x32_bf16 v[236:239], v[76:79], a[12:15], v[236:239]
  buffer_load_dwordx4 v103, s[80:83], s89 offen offset:3072 lds
  v_mfma_f32_16x16x32_bf16 v[240:243], v[76:79], a[16:19], v[240:243]
  s_cmp_eq_u32 s30, 1
  s_cselect_b32 s48, -23, 5
  s_cmp_eq_u32 s30, 3
  v_mfma_f32_16x16x32_bf16 v[244:247], v[76:79], a[20:23], v[244:247]
  s_cselect_b32 s48, 0x400, s48
  s_add_u32 s88, s88, s48
  s_lshl_b32 s89, s88, 15
  v_mfma_f32_16x16x32_bf16 v[248:251], v[76:79], a[24:27], v[248:251]
  s_lshl_b32 s90, s88, 14
  s_add_u32 s90, s90, s93
  v_mfma_f32_16x16x32_bf16 v[252:255], v[76:79], a[28:31], v[252:255]
  s_waitcnt lgkmcnt(0)
  s_cmp_lt_u32 s30, 2
  s_cbranch_scc0 L_o3x_ret
  s_cmp_eq_u32 s30, 1
  s_cbranch_scc1 L_f2chk
  s_waitcnt vmcnt(36) lgkmcnt(0)
  s_barrier
  s_cmp_lg_u32 s69, 0
  s_cbranch_scc1 L_o3x_w
  v_mov_b32 v110, 0x19000
  ds_read_b128 v[112:115], v110
  s_waitcnt lgkmcnt(0)
  v_or_b32 v112, v112, v113
  v_or3_b32 v112, v112, v114, v115
  v_cmp_ne_u32 vcc, 0, v112
  s_cbranch_vccnz L_goslow
  s_cmp_lg_u32 s24, 0
  s_cbranch_scc1 L_sig2_skip
  s_mov_b64 exec, 1
  v_mov_b32 v107, 0x10000
  v_mov_b32 v108, s95
  buffer_atomic_add v107, v108, s[76:79], 0 offen sc1
  s_mov_b64 exec, -1
L_sig2_skip:
L_o3x_w:
  s_branch L_o3x_ret
L_f2chk:
L_f2_spin:
  s_branch L_f2_first
L_f2_again:
  s_sleep 8
L_f2_first:
  buffer_load_dword v105, off, s[76:79], s101 sc1
  s_waitcnt vmcnt(0)
  v_readfirstlane_b32 s48, v105
  s_bfe_u32 s48, s48, 0x80010
  s_cmp_eq_u32 s48, 4
  s_cbranch_scc0 L_f2_again
L_f2_ok:
L_o3x_ret:
  s_waitcnt vmcnt(36)
  v_mfma_f32_16x16x32_bf16 v[128:131], v[80:83], a[32:35], v[128:131]
  v_mfma_f32_16x16x32_bf16 v[132:135], v[80:83], a[36:39], v[132:135]
  ds_read_b64_tr_b16 v[64:65], v96 offset:16384
  v_mfma_f32_16x16x32_bf16 v[136:139], v[80:83], a[40:43], v[136:139]
  buffer_load_dwordx4 a[64:67], v1, s[20:23], s90 offen offset:0 sc1
  v_mfma_f32_16x16x32_bf16 v[140:143], v[80:83], a[44:47], v[140:143]
  buffer_load_dwordx4 a[68:71], v1, s[20:23], s90 offen offset:1024 sc1
  v_mfma_f32_16x16x32_bf16 v[144:147], v[80:83], a[48:51], v[144:147]
  ds_read_b64_tr_b16 v[66:67], v96 offset:18432
  v_mfma_f32_16x16x32_bf16 v[148:151], v[80:83], a[52:55], v[148:151]
  v_mfma_f32_16x16x32_bf16 v[152:155], v[80:83], a[56:59], v[152:155]
  buffer_load_dwordx4 a[72:75], v1, s[20:23], s90 offen offset:2048 sc1
  v_mfma_f32_16x16x32_bf16 v[156:159], v[80:83], a[60:63], v[156:159]
  ds_read_b64_tr_b16 v[68:69], v97 offset:16384
  v_mfma_f32_16x16x32_bf16 v[160:163], v[84:87], a[32:35], v[160:163]
  v_mfma_f32_16x16x32_bf16 v[164:167], v[84:87], a[36:39], v[164:167]
  buffer_load_dwordx4 a[76:79], v1, s[20:23], s90 offen offset:3072 sc1
  v_mfma_f32_16x16x32_bf16 v[168:171], v[84:87], a[40:43], v[168:171]
  ds_read_b64_tr_b16 v[70:71], v97 offset:18432
  v_mfma_f32_16x16x32_bf16 v[172:175], v[84:87], a[44:47], v[172:175]
  buffer_load_dwordx4 a[80:83], v104, s[20:23], s90 offen offset:0 sc1
  v_mfma_f32_16x16x32_bf16 v[176:179], v[84:87], a[48:51], v[176:179]
  v_mfma_f32_16x16x32_bf16 v[180:183], v[84:87], a[52:55], v[180:183]
  ds_read_b64_tr_b16 v[72:73], v98 offset:16384
  v_mfma_f32_16x16x32_bf16 v[184:187], v[84:87], a[56:59], v[184:187]
  buffer_load_dwordx4 a[84:87], v104, s[20:23], s90 offen offset:1024 sc1
  v_mfma_f32_16x16x32_bf16 v[188:191], v[84:87], a[60:63], v[188:191]
  v_mfma_f32_16x16x32_bf16 v[192:195], v[88:91], a[32:35], v[192:195]
  ds_read_b64_tr_b16 v[74:75], v98 offset:18432
  v_mfma_f32_16x16x32_bf16 v[196:199], v[88:91], a[36:39], v[196:199]
  buffer_load_dwordx4 a[88:91], v104, s[20:23], s90 offen offset:2048 sc1
  v_mfma_f32_16x16x32_bf16 v[200:203], v[88:91], a[40:43], v[200:203]
  buffer_load_dwordx4 a[92:95], v104, s[20:23], s90 offen offset:3072 sc1
  v_mfma_f32_16x16x32_bf16 v[204:207], v[88:91], a[44:47], v[204:207]
  ds_read_b64_tr_b16 v[76:77], v99 offset:16384
  v_mfma_f32_16x16x32_bf16 v[208:211], v[88:91], a[48:51], v[208:211]
  s_add_u32 m0, s91, 0x0
  v_mfma_f32_16x16x32_bf16 v[212:215], v[88:91], a[52:55], v[212:215]
  buffer_load_dwordx4 v100, s[80:83], s89 offen offset:0 lds
  v_mfma_f32_16x16x32_bf16 v[216:219], v[88:91], a[56:59], v[216:219]
  ds_read_b64_tr_b16 v[78:79], v99 offset:18432
  v_mfma_f32_16x16x32_bf16 v[220:223], v[88:91], a[60:63], v[220:223]
  v_mfma_f32_16x16x32_bf16 v[224:227], v[92:95], a[32:35], v[224:227]
  buffer_load_dwordx4 v101, s[80:83], s89 offen offset:1024 lds
  v_mfma_f32_16x16x32_bf16 v[228:231], v[92:95], a[36:39], v[228:231]
  buffer_load_dwordx4 v102, s[80:83], s89 offen offset:2048 lds
  v_mfma_f32_16x16x32_bf16 v[232:235], v[92:95], a[40:43], v[232:235]
  v_mfma_f32_16x16x32_bf16 v[236:239], v[92:95], a[44:47], v[236:239]
  buffer_load_dwordx4 v103, s[80:83], s89 offen offset:3072 lds
  v_mfma_f32_16x16x32_bf16 v[240:243], v[92:95], a[48:51], v[240:243]
  s_add_u32 s88, s88, 1
  s_lshl_b32 s89, s88, 15
  s_lshl_b32 s90, s88, 14
  v_mfma_f32_16x16x32_bf16 v[244:247], v[92:95], a[52:55], v[244:247]
  s_add_u32 s90, s90, s93
  v_mfma_f32_16x16x32_bf16 v[248:251], v[92:95], a[56:59], v[248:251]
  v_mfma_f32_16x16x32_bf16 v[252:255], v[92:95], a[60:63], v[252:255]
  s_waitcnt lgkmcnt(0)
  s_waitcnt vmcnt(36)
  v_mfma_f32_16x16x32_bf16 v[128:131], v[64:67], a[128:131], v[128:131]
  v_mfma_f32_16x16x32_bf16 v[132:135], v[64:67], a[132:135], v[132:135]
  ds_read_b64_tr_b16 v[80:81], v96 offset:20480
  v_mfma_f32_16x16x32_bf16 v[136:139], v[64:67], a[136:139], v[136:139]
  buffer_load_dwordx4 a[96:99], v1, s[20:23], s90 offen offset:0 sc1
  v_mfma_f32_16x16x32_bf16 v[140:143], v[64:67], a[140:143], v[140:143]
  buffer_load_dwordx4 a[100:103], v1, s[20:23], s90 offen offset:1024 sc1
  v_mfma_f32_16x16x32_bf16 v[144:147], v[64:67], a[144:147], v[144:147]
  ds_read_b64_tr_b16 v[82:83], v96 offset:22528
  v_mfma_f32_16x16x32_bf16 v[148:151], v[64:67], a[148:151], v[148:151]
  v_mfma_f32_16x16x32_bf16 v[152:155], v[64:67], a[152:155], v[152:155]
  buffer_load_dwordx4 a[104:107], v1, s[20:23], s90 offen offset:2048 sc1
  v_mfma_f32_16x16x32_bf16 v[156:159], v[64:67], a[156:159], v[156:159]
  ds_read_b64_tr_b16 v[84:85], v97 offset:20480
  v_mfma_f32_16x16x32_bf16 v[160:163], v[68:71], a[128:131], v[160:163]
  v_mfma_f32_16x16x32_bf16 v[164:167], v[68:71], a[132:135], v[164:167]
  buffer_load_dwordx4 a[108:111], v1, s[20:23], s90 offen offset:3072 sc1
  v_mfma_f32_16x16x32_bf16 v[168:171], v[68:71], a[136:139], v[168:171]
  ds_read_b64_tr_b16 v[86:87], v97 offset:22528
  v_mfma_f32_16x16x32_bf16 v[172:175], v[68:71], a[140:143], v[172:175]
  buffer_load_dwordx4 a[112:115], v104, s[20:23], s90 offen offset:0 sc1
  v_mfma_f32_16x16x32_bf16 v[176:179], v[68:71], a[144:147], v[176:179]
  v_mfma_f32_16x16x32_bf16 v[180:183], v[68:71], a[148:151], v[180:183]
  ds_read_b64_tr_b16 v[88:89], v98 offset:20480
  v_mfma_f32_16x16x32_bf16 v[184:187], v[68:71], a[152:155], v[184:187]
  buffer_load_dwordx4 a[116:119], v104, s[20:23], s90 offen offset:1024 sc1
  v_mfma_f32_16x16x32_bf16 v[188:191], v[68:71], a[156:159], v[188:191]
  v_mfma_f32_16x16x32_bf16 v[192:195], v[72:75], a[128:131], v[192:195]
  ds_read_b64_tr_b16 v[90:91], v98 offset:22528
  v_mfma_f32_16x16x32_bf16 v[196:199], v[72:75], a[132:135], v[196:199]
  buffer_load_dwordx4 a[120:123], v104, s[20:23], s90 offen offset:2048 sc1
  v_mfma_f32_16x16x32_bf16 v[200:203], v[72:75], a[136:139], v[200:203]
  buffer_load_dwordx4 a[124:127], v104, s[20:23], s90 offen offset:3072 sc1
  v_mfma_f32_16x16x32_bf16 v[204:207], v[72:75], a[140:143], v[204:207]
  ds_read_b64_tr_b16 v[92:93], v99 offset:20480
  v_mfma_f32_16x16x32_bf16 v[208:211], v[72:75], a[144:147], v[208:211]
  s_add_u32 m0, s91, 0x1000
  v_mfma_f32_16x16x32_bf16 v[212:215], v[72:75], a[148:151], v[212:215]
  buffer_load_dwordx4 v100, s[80:83], s89 offen offset:0 lds
  v_mfma_f32_16x16x32_bf16 v[216:219], v[72:75], a[152:155], v[216:219]
  ds_read_b64_tr_b16 v[94:95], v99 offset:22528
  v_mfma_f32_16x16x32_bf16 v[220:223], v[72:75], a[156:159], v[220:223]
  v_mfma_f32_16x16x32_bf16 v[224:227], v[76:79], a[128:131], v[224:227]
  buffer_load_dwordx4 v101, s[80:83], s89 offen offset:1024 lds
  v_mfma_f32_16x16x32_bf16 v[228:231], v[76:79], a[132:135], v[228:231]
  buffer_load_dwordx4 v102, s[80:83], s89 offen offset:2048 lds
  v_mfma_f32_16x16x32_bf16 v[232:235], v[76:79], a[136:139], v[232:235]
  v_mfma_f32_16x16x32_bf16 v[236:239], v[76:79], a[140:143], v[236:239]
  buffer_load_dwordx4 v103, s[80:83], s89 offen offset:3072 lds
  v_mfma_f32_16x16x32_bf16 v[240:243], v[76:79], a[144:147], v[240:243]
  s_add_u32 s88, s88, 1
  s_lshl_b32 s89, s88, 15
  s_lshl_b32 s90, s88, 14
  v_mfma_f32_16x16x32_bf16 v[244:247], v[76:79], a[148:151], v[244:247]
  s_add_u32 s90, s90, s93
  v_mfma_f32_16x16x32_bf16 v[248:251], v[76:79], a[152:155], v[248:251]
  v_mfma_f32_16x16x32_bf16 v[252:255], v[76:79], a[156:159], v[252:255]
  s_waitcnt lgkmcnt(0)
  s_waitcnt vmcnt(36)
  v_mfma_f32_16x16x32_bf16 v[128:131], v[80:83], a[160:163], v[128:131]
  v_mfma_f32_16x16x32_bf16 v[132:135], v[80:83], a[164:167], v[132:135]
  ds_read_b64_tr_b16 v[64:65], v96 offset:24576
  v_mfma_f32_16x16x32_bf16 v[136:139], v[80:83], a[168:171], v[136:139]
  buffer_load_dwordx4 a[0:3], v1, s[20:23], s90 offen offset:0 sc1
  v_mfma_f32_16x16x32_bf16 v[140:143], v[80:83], a[172:175], v[140:143]
  buffer_load_dwordx4 a[4:7], v1, s[20:23], s90 offen offset:1024 sc1
  v_mfma_f32_16x16x32_bf16 v[144:147], v[80:83], a[176:179], v[144:147]
  ds_read_b64_tr_b16 v[66:67], v96 offset:26624
  v_mfma_f32_16x16x32_bf16 v[148:151], v[80:83], a[180:183], v[148:151]
  v_mfma_f32_16x16x32_bf16 v[152:155], v[80:83], a[184:187], v[152:155]
  buffer_load_dwordx4 a[8:11], v1, s[20:23], s90 offen offset:2048 sc1
  v_mfma_f32_16x16x32_bf16 v[156:159], v[80:83], a[188:191], v[156:159]
  ds_read_b64_tr_b16 v[68:69], v97 offset:24576
  v_mfma_f32_16x16x32_bf16 v[160:163], v[84:87], a[160:163], v[160:163]
  v_mfma_f32_16x16x32_bf16 v[164:167], v[84:87], a[164:167], v[164:167]
  buffer_load_dwordx4 a[12:15], v1, s[20:23], s90 offen offset:3072 sc1
  v_mfma_f32_16x16x32_bf16 v[168:171], v[84:87], a[168:171], v[168:171]
  ds_read_b64_tr_b16 v[70:71], v97 offset:26624
  v_mfma_f32_16x16x32_bf16 v[172:175], v[84:87], a[172:175], v[172:175]
  buffer_load_dwordx4 a[16:19], v104, s[20:23], s90 offen offset:0 sc1
  v_mfma_f32_16x16x32_bf16 v[176:179], v[84:87], a[176:179], v[176:179]
  v_mfma_f32_16x16x32_bf16 v[180:183], v[84:87], a[180:183], v[180:183]
  ds_read_b64_tr_b16 v[72:73], v98 offset:24576
  v_mfma_f32_16x16x32_bf16 v[184:187], v[84:87], a[184:187], v[184:187]
  buffer_load_dwordx4 a[20:23], v104, s[20:23], s90 offen offset:1024 sc1
  v_mfma_f32_16x16x32_bf16 v[188:191], v[84:87], a[188:191], v[188:191]
  v_mfma_f32_16x16x32_bf16 v[192:195], v[88:91], a[160:163], v[192:195]
  ds_read_b64_tr_b16 v[74:75], v98 offset:26624
  v_mfma_f32_16x16x32_bf16 v[196:199], v[88:91], a[164:167], v[196:199]
  buffer_load_dwordx4 a[24:27], v104, s[20:23], s90 offen offset:2048 sc1
  v_mfma_f32_16x16x32_bf16 v[200:203], v[88:91], a[168:171], v[200:203]
  buffer_load_dwordx4 a[28:31], v104, s[20:23], s90 offen offset:3072 sc1
  v_mfma_f32_16x16x32_bf16 v[204:207], v[88:91], a[172:175], v[204:207]
  ds_read_b64_tr_b16 v[76:77], v99 offset:24576
  v_mfma_f32_16x16x32_bf16 v[208:211], v[88:91], a[176:179], v[208:211]
  s_add_u32 m0, s91, 0x2000
  v_mfma_f32_16x16x32_bf16 v[212:215], v[88:91], a[180:183], v[212:215]
  buffer_load_dwordx4 v100, s[80:83], s89 offen offset:0 lds
  v_mfma_f32_16x16x32_bf16 v[216:219], v[88:91], a[184:187], v[216:219]
  ds_read_b64_tr_b16 v[78:79], v99 offset:26624
  v_mfma_f32_16x16x32_bf16 v[220:223], v[88:91], a[188:191], v[220:223]
  v_mfma_f32_16x16x32_bf16 v[224:227], v[92:95], a[160:163], v[224:227]
  buffer_load_dwordx4 v101, s[80:83], s89 offen offset:1024 lds
  v_mfma_f32_16x16x32_bf16 v[228:231], v[92:95], a[164:167], v[228:231]
  buffer_load_dwordx4 v102, s[80:83], s89 offen offset:2048 lds
  v_mfma_f32_16x16x32_bf16 v[232:235], v[92:95], a[168:171], v[232:235]
  v_mfma_f32_16x16x32_bf16 v[236:239], v[92:95], a[172:175], v[236:239]
  buffer_load_dwordx4 v103, s[80:83], s89 offen offset:3072 lds
  v_mfma_f32_16x16x32_bf16 v[240:243], v[92:95], a[176:179], v[240:243]
  s_add_u32 s88, s88, 1
  s_lshl_b32 s89, s88, 15
  s_lshl_b32 s90, s88, 14
  v_mfma_f32_16x16x32_bf16 v[244:247], v[92:95], a[180:183], v[244:247]
  s_add_u32 s90, s90, s93
  v_mfma_f32_16x16x32_bf16 v[248:251], v[92:95], a[184:187], v[248:251]
  v_mfma_f32_16x16x32_bf16 v[252:255], v[92:95], a[188:191], v[252:255]
  s_waitcnt lgkmcnt(0)
  s_waitcnt vmcnt(36)
  v_mfma_f32_16x16x32_bf16 v[128:131], v[64:67], a[192:195], v[128:131]
  v_mfma_f32_16x16x32_bf16 v[132:135], v[64:67], a[196:199], v[132:135]
  ds_read_b64_tr_b16 v[80:81], v96 offset:28672
  v_mfma_f32_16x16x32_bf16 v[136:139], v[64:67], a[200:203], v[136:139]
  buffer_load_dwordx4 a[32:35], v1, s[20:23], s90 offen offset:0 sc1
  v_mfma_f32_16x16x32_bf16 v[140:143], v[64:67], a[204:207], v[140:143]
  buffer_load_dwordx4 a[36:39], v1, s[20:23], s90 offen offset:1024 sc1
  v_mfma_f32_16x16x32_bf16 v[144:147], v[64:67], a[208:211], v[144:147]
  ds_read_b64_tr_b16 v[82:83], v96 offset:30720
  v_mfma_f32_16x16x32_bf16 v[148:151], v[64:67], a[212:215], v[148:151]
  v_mfma_f32_16x16x32_bf16 v[152:155], v[64:67], a[216:219], v[152:155]
  buffer_load_dwordx4 a[40:43], v1, s[20:23], s90 offen offset:2048 sc1
  v_mfma_f32_16x16x32_bf16 v[156:159], v[64:67], a[220:223], v[156:159]
  ds_read_b64_tr_b16 v[84:85], v97 offset:28672
  v_mfma_f32_16x16x32_bf16 v[160:163], v[68:71], a[192:195], v[160:163]
  v_mfma_f32_16x16x32_bf16 v[164:167], v[68:71], a[196:199], v[164:167]
  buffer_load_dwordx4 a[44:47], v1, s[20:23], s90 offen offset:3072 sc1
  v_mfma_f32_16x16x32_bf16 v[168:171], v[68:71], a[200:203], v[168:171]
  ds_read_b64_tr_b16 v[86:87], v97 offset:30720
  v_mfma_f32_16x16x32_bf16 v[172:175], v[68:71], a[204:207], v[172:175]
  buffer_load_dwordx4 a[48:51], v104, s[20:23], s90 offen offset:0 sc1
  v_mfma_f32_16x16x32_bf16 v[176:179], v[68:71], a[208:211], v[176:179]
  v_mfma_f32_16x16x32_bf16 v[180:183], v[68:71], a[212:215], v[180:183]
  ds_read_b64_tr_b16 v[88:89], v98 offset:28672
  v_mfma_f32_16x16x32_bf16 v[184:187], v[68:71], a[216:219], v[184:187]
  buffer_load_dwordx4 a[52:55], v104, s[20:23], s90 offen offset:1024 sc1
  v_mfma_f32_16x16x32_bf16 v[188:191], v[68:71], a[220:223], v[188:191]
  v_mfma_f32_16x16x32_bf16 v[192:195], v[72:75], a[192:195], v[192:195]
  ds_read_b64_tr_b16 v[90:91], v98 offset:30720
  v_mfma_f32_16x16x32_bf16 v[196:199], v[72:75], a[196:199], v[196:199]
  buffer_load_dwordx4 a[56:59], v104, s[20:23], s90 offen offset:2048 sc1
  v_mfma_f32_16x16x32_bf16 v[200:203], v[72:75], a[200:203], v[200:203]
  buffer_load_dwordx4 a[60:63], v104, s[20:23], s90 offen offset:3072 sc1
  v_mfma_f32_16x16x32_bf16 v[204:207], v[72:75], a[204:207], v[204:207]
  ds_read_b64_tr_b16 v[92:93], v99 offset:28672
  v_mfma_f32_16x16x32_bf16 v[208:211], v[72:75], a[208:211], v[208:211]
  s_add_u32 m0, s91, 0x3000
  v_mfma_f32_16x16x32_bf16 v[212:215], v[72:75], a[212:215], v[212:215]
  buffer_load_dwordx4 v100, s[80:83], s89 offen offset:0 lds
  v_mfma_f32_16x16x32_bf16 v[216:219], v[72:75], a[216:219], v[216:219]
  ds_read_b64_tr_b16 v[94:95], v99 offset:30720
  v_mfma_f32_16x16x32_bf16 v[220:223], v[72:75], a[220:223], v[220:223]
  v_mfma_f32_16x16x32_bf16 v[224:227], v[76:79], a[192:195], v[224:227]
  buffer_load_dwordx4 v101, s[80:83], s89 offen offset:1024 lds
  v_mfma_f32_16x16x32_bf16 v[228:231], v[76:79], a[196:199], v[228:231]
  buffer_load_dwordx4 v102, s[80:83], s89 offen offset:2048 lds
  v_mfma_f32_16x16x32_bf16 v[232:235], v[76:79], a[200:203], v[232:235]
  v_mfma_f32_16x16x32_bf16 v[236:239], v[76:79], a[204:207], v[236:239]
  buffer_load_dwordx4 v103, s[80:83], s89 offen offset:3072 lds
  v_mfma_f32_16x16x32_bf16 v[240:243], v[76:79], a[208:211], v[240:243]
  s_add_u32 s88, s88, 5
  s_lshl_b32 s89, s88, 15
  s_lshl_b32 s90, s88, 14
  v_mfma_f32_16x16x32_bf16 v[244:247], v[76:79], a[212:215], v[244:247]
  s_add_u32 s90, s90, s93
  v_mfma_f32_16x16x32_bf16 v[248:251], v[76:79], a[216:219], v[248:251]
  v_mfma_f32_16x16x32_bf16 v[252:255], v[76:79], a[220:223], v[252:255]
  s_waitcnt lgkmcnt(0)
  s_waitcnt vmcnt(36)
  v_mfma_f32_16x16x32_bf16 v[128:131], v[80:83], a[224:227], v[128:131]
  v_mfma_f32_16x16x32_bf16 v[132:135], v[80:83], a[228:231], v[132:135]
  ds_read_b64_tr_b16 v[64:65], v96 offset:0
  v_mfma_f32_16x16x32_bf16 v[136:139], v[80:83], a[232:235], v[136:139]
  buffer_load_dwordx4 a[128:131], v1, s[20:23], s90 offen offset:0 sc1
  v_mfma_f32_16x16x32_bf16 v[140:143], v[80:83], a[236:239], v[140:143]
  buffer_load_dwordx4 a[132:135], v1, s[20:23], s90 offen offset:1024 sc1
  v_mfma_f32_16x16x32_bf16 v[144:147], v[80:83], a[240:243], v[144:147]
  ds_read_b64_tr_b16 v[66:67], v96 offset:2048
  v_mfma_f32_16x16x32_bf16 v[148:151], v[80:83], a[244:247], v[148:151]
  v_mfma_f32_16x16x32_bf16 v[152:155], v[80:83], a[248:251], v[152:155]
  buffer_load_dwordx4 a[136:139], v1, s[20:23], s90 offen offset:2048 sc1
  v_mfma_f32_16x16x32_bf16 v[156:159], v[80:83], a[252:255], v[156:159]
  ds_read_b64_tr_b16 v[68:69], v97 offset:0
  v_mfma_f32_16x16x32_bf16 v[160:163], v[84:87], a[224:227], v[160:163]
  v_mfma_f32_16x16x32_bf16 v[164:167], v[84:87], a[228:231], v[164:167]
  buffer_load_dwordx4 a[140:143], v1, s[20:23], s90 offen offset:3072 sc1
  v_mfma_f32_16x16x32_bf16 v[168:171], v[84:87], a[232:235], v[168:171]
  ds_read_b64_tr_b16 v[70:71], v97 offset:2048
  v_mfma_f32_16x16x32_bf16 v[172:175], v[84:87], a[236:239], v[172:175]
  buffer_load_dwordx4 a[144:147], v104, s[20:23], s90 offen offset:0 sc1
  v_mfma_f32_16x16x32_bf16 v[176:179], v[84:87], a[240:243], v[176:179]
  v_mfma_f32_16x16x32_bf16 v[180:183], v[84:87], a[244:247], v[180:183]
  ds_read_b64_tr_b16 v[72:73], v98 offset:0
  v_mfma_f32_16x16x32_bf16 v[184:187], v[84:87], a[248:251], v[184:187]
  buffer_load_dwordx4 a[148:151], v104, s[20:23], s90 offen offset:1024 sc1
  v_mfma_f32_16x16x32_bf16 v[188:191], v[84:87], a[252:255], v[188:191]
  v_mfma_f32_16x16x32_bf16 v[192:195], v[88:91], a[224:227], v[192:195]
  ds_read_b64_tr_b16 v[74:75], v98 offset:2048
  v_mfma_f32_16x16x32_bf16 v[196:199], v[88:91], a[228:231], v[196:199]
  buffer_load_dwordx4 a[152:155], v104, s[20:23], s90 offen offset:2048 sc1
  v_mfma_f32_16x16x32_bf16 v[200:203], v[88:91], a[232:235], v[200:203]
  buffer_load_dwordx4 a[156:159], v104, s[20:23], s90 offen offset:3072 sc1
  v_mfma_f32_16x16x32_bf16 v[204:207], v[88:91], a[236:239], v[204:207]
  ds_read_b64_tr_b16 v[76:77], v99 offset:0
  v_mfma_f32_16x16x32_bf16 v[208:211], v[88:91], a[240:243], v[208:211]
  s_add_u32 m0, s91, 0x4000
  v_mfma_f32_16x16x32_bf16 v[212:215], v[88:91], a[244:247], v[212:215]
  buffer_load_dwordx4 v100, s[80:83], s89 offen offset:0 lds
  v_mfma_f32_16x16x32_bf16 v[216:219], v[88:91], a[248:251], v[216:219]
  ds_read_b64_tr_b16 v[78:79], v99 offset:2048
  v_mfma_f32_16x16x32_bf16 v[220:223], v[88:91], a[252:255], v[220:223]
  v_mfma_f32_16x16x32_bf16 v[224:227], v[92:95], a[224:227], v[224:227]
  buffer_load_dwordx4 v101, s[80:83], s89 offen offset:1024 lds
  v_mfma_f32_16x16x32_bf16 v[228:231], v[92:95], a[228:231], v[228:231]
  buffer_load_dwordx4 v102, s[80:83], s89 offen offset:2048 lds
  v_mfma_f32_16x16x32_bf16 v[232:235], v[92:95], a[232:235], v[232:235]
  v_mfma_f32_16x16x32_bf16 v[236:239], v[92:95], a[236:239], v[236:239]
  buffer_load_dwordx4 v103, s[80:83], s89 offen offset:3072 lds
  v_mfma_f32_16x16x32_bf16 v[240:243], v[92:95], a[240:243], v[240:243]
  s_add_u32 s88, s88, 1
  s_lshl_b32 s89, s88, 15
  s_lshl_b32 s90, s88, 14
  v_mfma_f32_16x16x32_bf16 v[244:247], v[92:95], a[244:247], v[244:247]
  s_add_u32 s90, s90, s93
  v_mfma_f32_16x16x32_bf16 v[248:251], v[92:95], a[248:251], v[248:251]
  v_mfma_f32_16x16x32_bf16 v[252:255], v[92:95], a[252:255], v[252:255]
  s_waitcnt lgkmcnt(0)
  s_cmp_lg_u32 s30, 0
  s_cbranch_scc1 L_poll2_ret
L_poll2_ret:
  s_add_u32 s30, s30, 1
  s_cmp_lt_u32 s30, 4
  s_cbranch_scc1 L_oloop
  s_waitcnt vmcnt(0)
  s_barrier
  s_lshl_b32 s49, s24, 15
  v_add_u32 v33, s49, v1
  s_lshl_b32 s48, s24, 11
  v_add_u32 v34, s48, v1
  v_add_u32 v35, 0x10000, v34
  v_add_u32 v36, 0x4000, v106
  s_nop 4
  ds_write_b128 v33, v[128:131] offset:0
  ds_write_b128 v33, v[132:135] offset:1024
  ds_write_b128 v33, v[136:139] offset:2048
  ds_write_b128 v33, v[140:143] offset:3072
  ds_write_b128 v33, v[144:147] offset:4096
  ds_write_b128 v33, v[148:151] offset:5120
  ds_write_b128 v33, v[152:155] offset:6144
  ds_write_b128 v33, v[156:159] offset:7168
  ds_write_b128 v33, v[160:163] offset:8192
  ds_write_b128 v33, v[164:167] offset:9216
  ds_write_b128 v33, v[168:171] offset:10240
  ds_write_b128 v33, v[172:175] offset:11264
  ds_write_b128 v33, v[176:179] offset:12288
  ds_write_b128 v33, v[180:183] offset:13312
  ds_write_b128 v33, v[184:187] offset:14336
  ds_write_b128 v33, v[188:191] offset:15360
  ds_write_b128 v33, v[192:195] offset:16384
  ds_write_b128 v33, v[196:199] offset:17408
  ds_write_b128 v33, v[200:203] offset:18432
  ds_write_b128 v33, v[204:207] offset:19456
  ds_write_b128 v33, v[208:211] offset:20480
  ds_write_b128 v33, v[212:215] offset:21504
  ds_write_b128 v33, v[216:219] offset:22528
  ds_write_b128 v33, v[220:223] offset:23552
  ds_write_b128 v33, v[224:227] offset:24576
  ds_write_b128 v33, v[228:231] offset:25600
  ds_write_b128 v33, v[232:235] offset:26624
  ds_write_b128 v33, v[236:239] offset:27648
  ds_write_b128 v33, v[240:243] offset:28672
  ds_write_b128 v33, v[244:247] offset:29696
  ds_write_b128 v33, v[248:251] offset:30720
  ds_write_b128 v33, v[252:255] offset:31744
  s_waitcnt lgkmcnt(0)
  s_barrier
  ds_read_b128 v[128:131], v34 offset:0
  ds_read_b128 v[132:135], v34 offset:1024
  ds_read_b128 v[136:139], v34 offset:8192
  ds_read_b128 v[140:143], v34 offset:9216
  ds_read_b128 v[144:147], v34 offset:16384
  ds_read_b128 v[148:151], v34 offset:17408
  ds_read_b128 v[152:155], v34 offset:24576
  ds_read_b128 v[156:159], v34 offset:25600
  ds_read_b128 v[160:163], v34 offset:32768
  ds_read_b128 v[164:167], v34 offset:33792
  ds_read_b128 v[168:171], v34 offset:40960
  ds_read_b128 v[172:175], v34 offset:41984
  ds_read_b128 v[176:179], v34 offset:49152
  ds_read_b128 v[180:183], v34 offset:50176
  ds_read_b128 v[184:187], v34 offset:57344
  ds_read_b128 v[188:191], v34 offset:58368
  s_waitcnt lgkmcnt(8)
  ds_read_b128 v[192:195], v35 offset:0
  ds_read_b128 v[196:199], v35 offset:1024
  ds_read_b128 v[200:203], v35 offset:8192
  ds_read_b128 v[204:207], v35 offset:9216
  ds_read_b128 v[208:211], v35 offset:16384
  ds_read_b128 v[212:215], v35 offset:17408
  ds_read_b128 v[216:219], v35 offset:24576
  ds_read_b128 v[220:223], v35 offset:25600
  ds_read_b128 v[224:227], v35 offset:32768
  ds_read_b128 v[228:231], v35 offset:33792
  ds_read_b128 v[232:235], v35 offset:40960
  ds_read_b128 v[236:239], v35 offset:41984
  ds_read_b128 v[240:243], v35 offset:49152
  ds_read_b128 v[244:247], v35 offset:50176
  ds_read_b128 v[248:251], v35 offset:57344
  ds_read_b128 v[252:255], v35 offset:58368
  s_waitcnt lgkmcnt(0)
  v_add_f32 v128, v128, v160
  v_add_f32 v192, v192, v224
  v_add_f32 v129, v129, v161
  v_add_f32 v193, v193, v225
  v_add_f32 v130, v130, v162
  v_add_f32 v194, v194, v226
  v_add_f32 v131, v131, v163
  v_add_f32 v195, v195, v227
  v_add_f32 v128, v128, v192
  v_add_f32 v129, v129, v193
  v_add_f32 v130, v130, v194
  v_add_f32 v131, v131, v195
  v_cvt_pk_bf16_f32 v64, v128, v129
  v_cvt_pk_bf16_f32 v65, v130, v131
  buffer_store_dwordx2 v[64:65], v106, s[84:87], s94 offen offset:0
  v_add_f32 v132, v132, v164
  v_add_f32 v196, v196, v228
  v_add_f32 v133, v133, v165
  v_add_f32 v197, v197, v229
  v_add_f32 v134, v134, v166
  v_add_f32 v198, v198, v230
  v_add_f32 v135, v135, v167
  v_add_f32 v199, v199, v231
  v_add_f32 v132, v132, v196
  v_add_f32 v133, v133, v197
  v_add_f32 v134, v134, v198
  v_add_f32 v135, v135, v199
  v_cvt_pk_bf16_f32 v66, v132, v133
  v_cvt_pk_bf16_f32 v67, v134, v135
  buffer_store_dwordx2 v[66:67], v36, s[84:87], s94 offen offset:0
  v_add_f32 v136, v136, v168
  v_add_f32 v200, v200, v232
  v_add_f32 v137, v137, v169
  v_add_f32 v201, v201, v233
  v_add_f32 v138, v138, v170
  v_add_f32 v202, v202, v234
  v_add_f32 v139, v139, v171
  v_add_f32 v203, v203, v235
  v_add_f32 v136, v136, v200
  v_add_f32 v137, v137, v201
  v_add_f32 v138, v138, v202
  v_add_f32 v139, v139, v203
  v_cvt_pk_bf16_f32 v68, v136, v137
  v_cvt_pk_bf16_f32 v69, v138, v139
  buffer_store_dwordx2 v[68:69], v106, s[84:87], s94 offen offset:32
  v_add_f32 v140, v140, v172
  v_add_f32 v204, v204, v236
  v_add_f32 v141, v141, v173
  v_add_f32 v205, v205, v237
  v_add_f32 v142, v142, v174
  v_add_f32 v206, v206, v238
  v_add_f32 v143, v143, v175
  v_add_f32 v207, v207, v239
  v_add_f32 v140, v140, v204
  v_add_f32 v141, v141, v205
  v_add_f32 v142, v142, v206
  v_add_f32 v143, v143, v207
  v_cvt_pk_bf16_f32 v70, v140, v141
  v_cvt_pk_bf16_f32 v71, v142, v143
  buffer_store_dwordx2 v[70:71], v36, s[84:87], s94 offen offset:32
  v_add_f32 v144, v144, v176
  v_add_f32 v208, v208, v240
  v_add_f32 v145, v145, v177
  v_add_f32 v209, v209, v241
  v_add_f32 v146, v146, v178
  v_add_f32 v210, v210, v242
  v_add_f32 v147, v147, v179
  v_add_f32 v211, v211, v243
  v_add_f32 v144, v144, v208
  v_add_f32 v145, v145, v209
  v_add_f32 v146, v146, v210
  v_add_f32 v147, v147, v211
  v_cvt_pk_bf16_f32 v72, v144, v145
  v_cvt_pk_bf16_f32 v73, v146, v147
  buffer_store_dwordx2 v[72:73], v106, s[84:87], s94 offen offset:64
  v_add_f32 v148, v148, v180
  v_add_f32 v212, v212, v244
  v_add_f32 v149, v149, v181
  v_add_f32 v213, v213, v245
  v_add_f32 v150, v150, v182
  v_add_f32 v214, v214, v246
  v_add_f32 v151, v151, v183
  v_add_f32 v215, v215, v247
  v_add_f32 v148, v148, v212
  v_add_f32 v149, v149, v213
  v_add_f32 v150, v150, v214
  v_add_f32 v151, v151, v215
  v_cvt_pk_bf16_f32 v74, v148, v149
  v_cvt_pk_bf16_f32 v75, v150, v151
  buffer_store_dwordx2 v[74:75], v36, s[84:87], s94 offen offset:64
  v_add_f32 v152, v152, v184
  v_add_f32 v216, v216, v248
  v_add_f32 v153, v153, v185
  v_add_f32 v217, v217, v249
  v_add_f32 v154, v154, v186
  v_add_f32 v218, v218, v250
  v_add_f32 v155, v155, v187
  v_add_f32 v219, v219, v251
  v_add_f32 v152, v152, v216
  v_add_f32 v153, v153, v217
  v_add_f32 v154, v154, v218
  v_add_f32 v155, v155, v219
  v_cvt_pk_bf16_f32 v76, v152, v153
  v_cvt_pk_bf16_f32 v77, v154, v155
  buffer_store_dwordx2 v[76:77], v106, s[84:87], s94 offen offset:96
  v_add_f32 v156, v156, v188
  v_add_f32 v220, v220, v252
  v_add_f32 v157, v157, v189
  v_add_f32 v221, v221, v253
  v_add_f32 v158, v158, v190
  v_add_f32 v222, v222, v254
  v_add_f32 v159, v159, v191
  v_add_f32 v223, v223, v255
  v_add_f32 v156, v156, v220
  v_add_f32 v157, v157, v221
  v_add_f32 v158, v158, v222
  v_add_f32 v159, v159, v223
  v_cvt_pk_bf16_f32 v78, v156, v157
  v_cvt_pk_bf16_f32 v79, v158, v159
  buffer_store_dwordx2 v[78:79], v36, s[84:87], s94 offen offset:96
L_end:
  s_endpgm
L_endit:
  s_cmp_eq_u32 s30, 10
  s_cbranch_scc1 L_sig1
  s_cmp_lg_u32 s24, 0
  s_cbranch_scc1 L_endit_ret
  buffer_load_dwordx4 v[24:27], off, s[76:79], s92 sc1
  s_branch L_endit_ret
L_sig1:
  v_add_u32 v26, -256, v30
  ds_read_b32 v27, v26
  s_waitcnt lgkmcnt(0)
  v_cmp_ne_u32 vcc, 0, v27
  s_cbranch_vccnz L_endit_ret
  s_mov_b32 s3, 1
  s_cmp_lg_u32 s24, 0
  s_cbranch_scc1 L_sig1_skip
  s_mov_b64 exec, 1
  v_mov_b32 v26, 1
  v_mov_b32 v27, s95
  buffer_atomic_add v26, v27, s[76:79], 0 offen sc1
  s_mov_b64 exec, -1
L_sig1_skip:
  s_branch L_endit_ret
L_spin1:
  ds_read_b32 v0, v30
  s_waitcnt lgkmcnt(0)
  v_cmp_gt_u32 vcc, s68, v0
  s_cbranch_vccnz L_spin1
  s_branch L_spin1_ret
L_spin2:
  ds_read_b32 v0, v30
  s_waitcnt lgkmcnt(0)
  v_cmp_gt_u32 vcc, s68, v0
  s_cbranch_vccnz L_spin2
  s_branch L_spin2_ret
L_spin3:
  ds_read_b32 v0, v30
  s_waitcnt lgkmcnt(0)
  v_cmp_gt_u32 vcc, s68, v0
  s_cbranch_vccnz L_spin3
  s_branch L_spin3_ret
L_spin4:
  ds_read_b32 v0, v30
  s_waitcnt lgkmcnt(0)
  v_cmp_gt_u32 vcc, s68, v0
  s_cbranch_vccnz L_spin4
  s_branch L_spin4_ret
L_spin5:
  ds_read_b32 v0, v30
  s_waitcnt lgkmcnt(0)
  v_cmp_gt_u32 vcc, s68, v0
  s_cbranch_vccnz L_spin5
  s_branch L_spin5_ret
L_spin6:
  ds_read_b32 v0, v30
  s_waitcnt lgkmcnt(0)
  v_cmp_gt_u32 vcc, s68, v0
  s_cbranch_vccnz L_spin6
  s_branch L_spin6_ret
L_spin7:
  ds_read_b32 v0, v30
  s_waitcnt lgkmcnt(0)
  v_cmp_gt_u32 vcc, s68, v0
  s_cbranch_vccnz L_spin7
  s_branch L_spin7_ret
L_spin8:
  ds_read_b32 v0, v30
  s_waitcnt lgkmcnt(0)
  v_cmp_gt_u32 vcc, s68, v0
  s_cbranch_vccnz L_spin8
  s_branch L_spin8_ret
L_spin9:
  ds_read_b32 v0, v30
  s_waitcnt lgkmcnt(0)
  v_cmp_gt_u32 vcc, s68, v0
  s_cbranch_vccnz L_spin9
  s_branch L_spin9_ret
L_code_hot_end:
L_goslow:
  s_waitcnt vmcnt(0) lgkmcnt(0)
  s_barrier
  s_mov_b32 s69, 1
  s_branch L_restart
L_slow:
  s_mov_b32 s54, 0
  v_and_b32 v2, 0xffff7fff, v2
  v_and_b32 v3, 0xffff7fff, v3
  v_and_b32 v4, 0xffff7fff, v4
  v_and_b32 v5, 0xffff7fff, v5
  v_and_b32 v6, 0xffff7fff, v6
  v_and_b32 v7, 0xffff7fff, v7
  v_and_b32 v8, 0xffff7fff, v8
  v_and_b32 v9, 0xffff7fff, v9
  v_and_b32 v10, 0xffff7fff, v10
  v_and_b32 v11, 0xffff7fff, v11
  v_and_b32 v12, 0xffff7fff, v12
  v_and_b32 v13, 0xffff7fff, v13
  s_cmp_eq_u32 s3, 0
  s_cbranch_scc1 L_slow_head
  s_mov_b32 s54, 1
  s_add_u32 s31, s31, 0x10000
  v_accvgpr_mov_b32 a0, a64
  v_accvgpr_mov_b32 a1, a65
  v_accvgpr_mov_b32 a2, a66
  v_accvgpr_mov_b32 a3, a67
  v_accvgpr_mov_b32 a4, a68
  v_accvgpr_mov_b32 a5, a69
  v_accvgpr_mov_b32 a6, a70
  v_accvgpr_mov_b32 a7, a71
  v_accvgpr_mov_b32 a8, a72
  v_accvgpr_mov_b32 a9, a73
  v_accvgpr_mov_b32 a10, a74
  v_accvgpr_mov_b32 a11, a75
  v_accvgpr_mov_b32 a12, a76
  v_accvgpr_mov_b32 a13, a77
  v_accvgpr_mov_b32 a14, a78
  v_accvgpr_mov_b32 a15, a79
  v_accvgpr_mov_b32 a16, a80
  v_accvgpr_mov_b32 a17, a81
  v_accvgpr_mov_b32 a18, a82
  v_accvgpr_mov_b32 a19, a83
  v_accvgpr_mov_b32 a20, a84
  v_accvgpr_mov_b32 a21, a85
  v_accvgpr_mov_b32 a22, a86
  v_accvgpr_mov_b32 a23, a87
  v_accvgpr_mov_b32 a24, a88
  v_accvgpr_mov_b32 a25, a89
  v_accvgpr_mov_b32 a26, a90
  v_accvgpr_mov_b32 a27, a91
  v_accvgpr_mov_b32 a28, a92
  v_accvgpr_mov_b32 a29, a93
  v_accvgpr_mov_b32 a30, a94
  v_accvgpr_mov_b32 a31, a95
  v_accvgpr_mov_b32 a32, a96
  v_accvgpr_mov_b32 a33, a97
  v_accvgpr_mov_b32 a34, a98
  v_accvgpr_mov_b32 a35, a99
  v_accvgpr_mov_b32 a36, a100
  v_accvgpr_mov_b32 a37, a101
  v_accvgpr_mov_b32 a38, a102
  v_accvgpr_mov_b32 a39, a103
  v_accvgpr_mov_b32 a40, a104
  v_accvgpr_mov_b32 a41, a105
  v_accvgpr_mov_b32 a42, a106
  v_accvgpr_mov_b32 a43, a107
  v_accvgpr_mov_b32 a44, a108
  v_accvgpr_mov_b32 a45, a109
  v_accvgpr_mov_b32 a46, a110
  v_accvgpr_mov_b32 a47, a111
  v_accvgpr_mov_b32 a48, a112
  v_accvgpr_mov_b32 a49, a113
  v_accvgpr_mov_b32 a50, a114
  v_accvgpr_mov_b32 a51, a115
  v_accvgpr_mov_b32 a52, a116
  v_accvgpr_mov_b32 a53, a117
  v_accvgpr_mov_b32 a54, a118
  v_accvgpr_mov_b32 a55, a119
  v_accvgpr_mov_b32 a56, a120
  v_accvgpr_mov_b32 a57, a121
  v_accvgpr_mov_b32 a58, a122
  v_accvgpr_mov_b32 a59, a123
  v_accvgpr_mov_b32 a60, a124
  v_accvgpr_mov_b32 a61, a125
  v_accvgpr_mov_b32 a62, a126
  v_accvgpr_mov_b32 a63, a127
L_slow_head:
  v_mov_b32 v32, 0xff800000
  v_mov_b32 v36, 0xff800000
  v_mov_b32 v40, 0xff800000
  v_mov_b32 v44, 0xff800000
  v_mov_b32 v128, 0
  v_mov_b32 v129, 0
  v_mov_b32 v130, 0
  v_mov_b32 v131, 0
  v_mov_b32 v132, 0
  v_mov_b32 v133, 0
  v_mov_b32 v134, 0
  v_mov_b32 v135, 0
  v_mov_b32 v136, 0
  v_mov_b32 v137, 0
  v_mov_b32 v138, 0
  v_mov_b32 v139, 0
  v_mov_b32 v140, 0
  v_mov_b32 v141, 0
  v_mov_b32 v142, 0
  v_mov_b32 v143, 0
  v_mov_b32 v144, 0
  v_mov_b32 v145, 0
  v_mov_b32 v146, 0
  v_mov_b32 v147, 0
  v_mov_b32 v148, 0
  v_mov_b32 v149, 0
  v_mov_b32 v150, 0
  v_mov_b32 v151, 0
  v_mov_b32 v152, 0
  v_mov_b32 v153, 0
  v_mov_b32 v154, 0
  v_mov_b32 v155, 0
  v_mov_b32 v156, 0
  v_mov_b32 v157, 0
  v_mov_b32 v158, 0
  v_mov_b32 v159, 0
  v_mov_b32 v160, 0
  v_mov_b32 v161, 0
  v_mov_b32 v162, 0
  v_mov_b32 v163, 0
  v_mov_b32 v164, 0
  v_mov_b32 v165, 0
  v_mov_b32 v166, 0
  v_mov_b32 v167, 0
  v_mov_b32 v168, 0
  v_mov_b32 v169, 0
  v_mov_b32 v170, 0
  v_mov_b32 v171, 0
  v_mov_b32 v172, 0
  v_mov_b32 v173, 0
  v_mov_b32 v174, 0
  v_mov_b32 v175, 0
  v_mov_b32 v176, 0
  v_mov_b32 v177, 0
  v_mov_b32 v178, 0
  v_mov_b32 v179, 0
  v_mov_b32 v180, 0
  v_mov_b32 v181, 0
  v_mov_b32 v182, 0
  v_mov_b32 v183, 0
  v_mov_b32 v184, 0
  v_mov_b32 v185, 0
  v_mov_b32 v186, 0
  v_mov_b32 v187, 0
  v_mov_b32 v188, 0
  v_mov_b32 v189, 0
  v_mov_b32 v190, 0
  v_mov_b32 v191, 0
  v_mov_b32 v192, 0
  v_mov_b32 v193, 0
  v_mov_b32 v194, 0
  v_mov_b32 v195, 0
  v_mov_b32 v196, 0
  v_mov_b32 v197, 0
  v_mov_b32 v198, 0
  v_mov_b32 v199, 0
  v_mov_b32 v200, 0
  v_mov_b32 v201, 0
  v_mov_b32 v202, 0
  v_mov_b32 v203, 0
  v_mov_b32 v204, 0
  v_mov_b32 v205, 0
  v_mov_b32 v206, 0
  v_mov_b32 v207, 0
  v_mov_b32 v208, 0
  v_mov_b32 v209, 0
  v_mov_b32 v210, 0
  v_mov_b32 v211, 0
  v_mov_b32 v212, 0
  v_mov_b32 v213, 0
  v_mov_b32 v214, 0
  v_mov_b32 v215, 0
  v_mov_b32 v216, 0
  v_mov_b32 v217, 0
  v_mov_b32 v218, 0
  v_mov_b32 v219, 0
  v_mov_b32 v220, 0
  v_mov_b32 v221, 0
  v_mov_b32 v222, 0
  v_mov_b32 v223, 0
  v_mov_b32 v224, 0
  v_mov_b32 v225, 0
  v_mov_b32 v226, 0
  v_mov_b32 v227, 0
  v_mov_b32 v228, 0
  v_mov_b32 v229, 0
  v_mov_b32 v230, 0
  v_mov_b32 v231, 0
  v_mov_b32 v232, 0
  v_mov_b32 v233, 0
  v_mov_b32 v234, 0
  v_mov_b32 v235, 0
  v_mov_b32 v236, 0
  v_mov_b32 v237, 0
  v_mov_b32 v238, 0
  v_mov_b32 v239, 0
  v_mov_b32 v240, 0
  v_mov_b32 v241, 0
  v_mov_b32 v242, 0
  v_mov_b32 v243, 0
  v_mov_b32 v244, 0
  v_mov_b32 v245, 0
  v_mov_b32 v246, 0
  v_mov_b32 v247, 0
  v_mov_b32 v248, 0
  v_mov_b32 v249, 0
  v_mov_b32 v250, 0
  v_mov_b32 v251, 0
  v_mov_b32 v252, 0
  v_mov_b32 v253, 0
  v_mov_b32 v254, 0
  v_mov_b32 v255, 0
  v_mov_b32 v48, 0
  v_mov_b32 v49, 0
  v_mov_b32 v50, 0
  v_mov_b32 v51, 0
  v_mov_b32 v52, 0
  v_mov_b32 v53, 0
  v_mov_b32 v54, 0
  v_mov_b32 v55, 0
  v_mov_b32 v56, 0
  v_mov_b32 v57, 0
  v_mov_b32 v58, 0
  v_mov_b32 v59, 0
  v_mov_b32 v60, 0
  v_mov_b32 v61, 0
  v_mov_b32 v62, 0
  v_mov_b32 v63, 0
  s_lshl_b32 s26, s54, 18
  s_add_u32 s26, s26, s25
  s_mov_b32 s27, s26
  s_mov_b32 s30, 0
L_slow_tile:
  s_waitcnt vmcnt(0) lgkmcnt(0)
  s_barrier
  s_mov_b32 s29, s25
  s_mov_b32 s65, s25
  s_mov_b32 m0, s29
  s_nop 0
  buffer_load_dwordx4 v14, s[4:7], s26 offen offset:0 nt lds
  buffer_load_dwordx4 v15, s[4:7], s26 offen offset:1024 nt lds
  buffer_load_dwordx4 v16, s[4:7], s26 offen offset:2048 nt lds
  buffer_load_dwordx4 v17, s[4:7], s26 offen offset:3072 nt lds
  s_add_u32 s29, s29, 0x4000
  s_and_b32 s29, s29, 0xffff
  s_add_u32 s26, s26, 0x4000
  s_add_u32 m0, s65, 0x10000
  s_nop 0
  buffer_load_dwordx4 v18, s[8:11], s27 offen offset:0 nt lds
  buffer_load_dwordx4 v19, s[8:11], s27 offen offset:1024 nt lds
  buffer_load_dwordx4 v18, s[8:11], s27 offen offset:2048 nt lds
  buffer_load_dwordx4 v19, s[8:11], s27 offen offset:3072 nt lds
  s_add_u32 s65, s65, 0x4000
  s_and_b32 s65, s65, 0xffff
  s_add_u32 s27, s27, 0x4000
  s_waitcnt vmcnt(0)
  s_barrier
  ds_read_b128 a[128:131], v2 offset:0
  ds_read_b128 a[132:135], v3 offset:0
  ds_read_b128 a[136:139], v4 offset:0
  ds_read_b128 a[140:143], v5 offset:0
  ds_read_b128 a[144:147], v2 offset:4096
  ds_read_b128 a[148:151], v3 offset:4096
  ds_read_b128 a[152:155], v4 offset:4096
  ds_read_b128 a[156:159], v5 offset:4096
  ds_read_b64_tr_b16 a[160:161], v6 offset:0
  ds_read_b64_tr_b16 a[162:163], v6 offset:4096
  ds_read_b64_tr_b16 a[164:165], v7 offset:0
  ds_read_b64_tr_b16 a[166:167], v7 offset:4096
  ds_read_b64_tr_b16 a[168:169], v8 offset:0
  ds_read_b64_tr_b16 a[170:171], v8 offset:4096
  ds_read_b64_tr_b16 a[172:173], v9 offset:0
  ds_read_b64_tr_b16 a[174:175], v9 offset:4096
  ds_read_b64_tr_b16 a[176:177], v10 offset:0
  ds_read_b64_tr_b16 a[178:179], v10 offset:4096
  ds_read_b64_tr_b16 a[180:181], v11 offset:0
  ds_read_b64_tr_b16 a[182:183], v11 offset:4096
  ds_read_b64_tr_b16 a[184:185], v12 offset:0
  ds_read_b64_tr_b16 a[186:187], v12 offset:4096
  ds_read_b64_tr_b16 a[188:189], v13 offset:0
  ds_read_b64_tr_b16 a[190:191], v13 offset:4096
  s_waitcnt lgkmcnt(0)
  v_mfma_f32_16x16x32_bf16 v[64:67], a[128:131], a[0:3], 0
  v_mfma_f32_16x16x32_bf16 v[64:67], a[132:135], a[16:19], v[64:67]
  v_mfma_f32_16x16x32_bf16 v[64:67], a[136:139], a[32:35], v[64:67]
  v_mfma_f32_16x16x32_bf16 v[64:67], a[140:143], a[48:51], v[64:67]
  v_mfma_f32_16x16x32_bf16 v[68:71], a[144:147], a[0:3], 0
  v_mfma_f32_16x16x32_bf16 v[68:71], a[148:151], a[16:19], v[68:71]
  v_mfma_f32_16x16x32_bf16 v[68:71], a[152:155], a[32:35], v[68:71]
  v_mfma_f32_16x16x32_bf16 v[68:71], a[156:159], a[48:51], v[68:71]
  v_mfma_f32_16x16x32_bf16 v[72:75], a[128:131], a[4:7], 0
  v_mfma_f32_16x16x32_bf16 v[72:75], a[132:135], a[20:23], v[72:75]
  v_mfma_f32_16x16x32_bf16 v[72:75], a[136:139], a[36:39], v[72:75]
  v_mfma_f32_16x16x32_bf16 v[72:75], a[140:143], a[52:55], v[72:75]
  v_mfma_f32_16x16x32_bf16 v[76:79], a[144:147], a[4:7], 0
  v_mfma_f32_16x16x32_bf16 v[76:79], a[148:151], a[20:23], v[76:79]
  v_mfma_f32_16x16x32_bf16 v[76:79], a[152:155], a[36:39], v[76:79]
  v_mfma_f32_16x16x32_bf16 v[76:79], a[156:159], a[52:55], v[76:79]
  v_mfma_f32_16x16x32_bf16 v[80:83], a[128:131], a[8:11], 0
  v_mfma_f32_16x16x32_bf16 v[80:83], a[132:135], a[24:27], v[80:83]
  v_mfma_f32_16x16x32_bf16 v[80:83], a[136:139], a[40:43], v[80:83]
  v_mfma_f32_16x16x32_bf16 v[80:83], a[140:143], a[56:59], v[80:83]
  v_mfma_f32_16x16x32_bf16 v[84:87], a[144:147], a[8:11], 0
  v_mfma_f32_16x16x32_bf16 v[84:87], a[148:151], a[24:27], v[84:87]
  v_mfma_f32_16x16x32_bf16 v[84:87], a[152:155], a[40:43], v[84:87]
  v_mfma_f32_16x16x32_bf16 v[84:87], a[156:159], a[56:59], v[84:87]
  v_mfma_f32_16x16x32_bf16 v[88:91], a[128:131], a[12:15], 0
  v_mfma_f32_16x16x32_bf16 v[88:91], a[132:135], a[28:31], v[88:91]
  v_mfma_f32_16x16x32_bf16 v[88:91], a[136:139], a[44:47], v[88:91]
  v_mfma_f32_16x16x32_bf16 v[88:91], a[140:143], a[60:63], v[88:91]
  v_mfma_f32_16x16x32_bf16 v[92:95], a[144:147], a[12:15], 0
  v_mfma_f32_16x16x32_bf16 v[92:95], a[148:151], a[28:31], v[92:95]
  v_mfma_f32_16x16x32_bf16 v[92:95], a[152:155], a[44:47], v[92:95]
  v_mfma_f32_16x16x32_bf16 v[92:95], a[156:159], a[60:63], v[92:95]
  v_max3_f32 v22, v64, v65, v66
  v_max3_f32 v22, v22, v67, v68
  v_max3_f32 v22, v22, v69, v70
  v_max3_f32 v22, v22, v71, v32
  v_mov_b32 v23, v22
  s_nop 0
  s_nop 0
  v_permlane16_swap_b32 v22, v23
  v_max_f32 v22, v22, v23
  v_mov_b32 v23, v22
  s_nop 0
  s_nop 0
  v_permlane32_swap_b32 v22, v23
  v_max_f32 v22, v22, v23
  v_sub_f32 v24, v32, v22
  v_exp_f32 v24, v24
  v_mov_b32 v32, v22
  v_sub_f32 v64, v64, v22
  v_sub_f32 v65, v65, v22
  v_sub_f32 v66, v66, v22
  v_sub_f32 v67, v67, v22
  v_sub_f32 v68, v68, v22
  v_sub_f32 v69, v69, v22
  v_sub_f32 v70, v70, v22
  v_sub_f32 v71, v71, v22
  v_exp_f32 v64, v64
  v_exp_f32 v65, v65
  v_exp_f32 v66, v66
  v_exp_f32 v67, v67
  v_exp_f32 v68, v68
  v_exp_f32 v69, v69
  v_exp_f32 v70, v70
  v_exp_f32 v71, v71
  v_cvt_pk_bf16_f32 v96, v64, v65
  v_cvt_pk_bf16_f32 v97, v66, v67
  v_cvt_pk_bf16_f32 v98, v68, v69
  v_cvt_pk_bf16_f32 v99, v70, v71
  v_mul_f32 v128, v128, v24
  v_mul_f32 v129, v129, v24
  v_mul_f32 v130, v130, v24
  v_mul_f32 v131, v131, v24
  v_mul_f32 v144, v144, v24
  v_mul_f32 v145, v145, v24
  v_mul_f32 v146, v146, v24
  v_mul_f32 v147, v147, v24
  v_mul_f32 v160, v160, v24
  v_mul_f32 v161, v161, v24
  v_mul_f32 v162, v162, v24
  v_mul_f32 v163, v163, v24
  v_mul_f32 v176, v176, v24
  v_mul_f32 v177, v177, v24
  v_mul_f32 v178, v178, v24
  v_mul_f32 v179, v179, v24
  v_mul_f32 v192, v192, v24
  v_mul_f32 v193, v193, v24
  v_mul_f32 v194, v194, v24
  v_mul_f32 v195, v195, v24
  v_mul_f32 v208, v208, v24
  v_mul_f32 v209, v209, v24
  v_mul_f32 v210, v210, v24
  v_mul_f32 v211, v211, v24
  v_mul_f32 v224, v224, v24
  v_mul_f32 v225, v225, v24
  v_mul_f32 v226, v226, v24
  v_mul_f32 v227, v227, v24
  v_mul_f32 v240, v240, v24
  v_mul_f32 v241, v241, v24
  v_mul_f32 v242, v242, v24
  v_mul_f32 v243, v243, v24
  v_mul_f32 v48, v48, v24
  v_mul_f32 v49, v49, v24
  v_mul_f32 v50, v50, v24
  v_mul_f32 v51, v51, v24
  v_max3_f32 v22, v72, v73, v74
  v_max3_f32 v22, v22, v75, v76
  v_max3_f32 v22, v22, v77, v78
  v_max3_f32 v22, v22, v79, v36
  v_mov_b32 v23, v22
  s_nop 0
  s_nop 0
  v_permlane16_swap_b32 v22, v23
  v_max_f32 v22, v22, v23
  v_mov_b32 v23, v22
  s_nop 0
  s_nop 0
  v_permlane32_swap_b32 v22, v23
  v_max_f32 v22, v22, v23
  v_sub_f32 v24, v36, v22
  v_exp_f32 v24, v24
  v_mov_b32 v36, v22
  v_sub_f32 v72, v72, v22
  v_sub_f32 v73, v73, v22
  v_sub_f32 v74, v74, v22
  v_sub_f32 v75, v75, v22
  v_sub_f32 v76, v76, v22
  v_sub_f32 v77, v77, v22
  v_sub_f32 v78, v78, v22
  v_sub_f32 v79, v79, v22
  v_exp_f32 v72, v72
  v_exp_f32 v73, v73
  v_exp_f32 v74, v74
  v_exp_f32 v75, v75
  v_exp_f32 v76, v76
  v_exp_f32 v77, v77
  v_exp_f32 v78, v78
  v_exp_f32 v79, v79
  v_cvt_pk_bf16_f32 v100, v72, v73
  v_cvt_pk_bf16_f32 v101, v74, v75
  v_cvt_pk_bf16_f32 v102, v76, v77
  v_cvt_pk_bf16_f32 v103, v78, v79
  v_mul_f32 v132, v132, v24
  v_mul_f32 v133, v133, v24
  v_mul_f32 v134, v134, v24
  v_mul_f32 v135, v135, v24
  v_mul_f32 v148, v148, v24
  v_mul_f32 v149, v149, v24
  v_mul_f32 v150, v150, v24
  v_mul_f32 v151, v151, v24
  v_mul_f32 v164, v164, v24
  v_mul_f32 v165, v165, v24
  v_mul_f32 v166, v166, v24
  v_mul_f32 v167, v167, v24
  v_mul_f32 v180, v180, v24
  v_mul_f32 v181, v181, v24
  v_mul_f32 v182, v182, v24
  v_mul_f32 v183, v183, v24
  v_mul_f32 v196, v196, v24
  v_mul_f32 v197, v197, v24
  v_mul_f32 v198, v198, v24
  v_mul_f32 v199, v199, v24
  v_mul_f32 v212, v212, v24
  v_mul_f32 v213, v213, v24
  v_mul_f32 v214, v214, v24
  v_mul_f32 v215, v215, v24
  v_mul_f32 v228, v228, v24
  v_mul_f32 v229, v229, v24
  v_mul_f32 v230, v230, v24
  v_mul_f32 v231, v231, v24
  v_mul_f32 v244, v244, v24
  v_mul_f32 v245, v245, v24
  v_mul_f32 v246, v246, v24
  v_mul_f32 v247, v247, v24
  v_mul_f32 v52, v52, v24
  v_mul_f32 v53, v53, v24
  v_mul_f32 v54, v54, v24
  v_mul_f32 v55, v55, v24
  v_max3_f32 v22, v80, v81, v82
  v_max3_f32 v22, v22, v83, v84
  v_max3_f32 v22, v22, v85, v86
  v_max3_f32 v22, v22, v87, v40
  v_mov_b32 v23, v22
  s_nop 0
  s_nop 0
  v_permlane16_swap_b32 v22, v23
  v_max_f32 v22, v22, v23
  v_mov_b32 v23, v22
  s_nop 0
  s_nop 0
  v_permlane32_swap_b32 v22, v23
  v_max_f32 v22, v22, v23
  v_sub_f32 v24, v40, v22
  v_exp_f32 v24, v24
  v_mov_b32 v40, v22
  v_sub_f32 v80, v80, v22
  v_sub_f32 v81, v81, v22
  v_sub_f32 v82, v82, v22
  v_sub_f32 v83, v83, v22
  v_sub_f32 v84, v84, v22
  v_sub_f32 v85, v85, v22
  v_sub_f32 v86, v86, v22
  v_sub_f32 v87, v87, v22
  v_exp_f32 v80, v80
  v_exp_f32 v81, v81
  v_exp_f32 v82, v82
  v_exp_f32 v83, v83
  v_exp_f32 v84, v84
  v_exp_f32 v85, v85
  v_exp_f32 v86, v86
  v_exp_f32 v87, v87
  v_cvt_pk_bf16_f32 v104, v80, v81
  v_cvt_pk_bf16_f32 v105, v82, v83
  v_cvt_pk_bf16_f32 v106, v84, v85
  v_cvt_pk_bf16_f32 v107, v86, v87
  v_mul_f32 v136, v136, v24
  v_mul_f32 v137, v137, v24
  v_mul_f32 v138, v138, v24
  v_mul_f32 v139, v139, v24
  v_mul_f32 v152, v152, v24
  v_mul_f32 v153, v153, v24
  v_mul_f32 v154, v154, v24
  v_mul_f32 v155, v155, v24
  v_mul_f32 v168, v168, v24
  v_mul_f32 v169, v169, v24
  v_mul_f32 v170, v170, v24
  v_mul_f32 v171, v171, v24
  v_mul_f32 v184, v184, v24
  v_mul_f32 v185, v185, v24
  v_mul_f32 v186, v186, v24
  v_mul_f32 v187, v187, v24
  v_mul_f32 v200, v200, v24
  v_mul_f32 v201, v201, v24
  v_mul_f32 v202, v202, v24
  v_mul_f32 v203, v203, v24
  v_mul_f32 v216, v216, v24
  v_mul_f32 v217, v217, v24
  v_mul_f32 v218, v218, v24
  v_mul_f32 v219, v219, v24
  v_mul_f32 v232, v232, v24
  v_mul_f32 v233, v233, v24
  v_mul_f32 v234, v234, v24
  v_mul_f32 v235, v235, v24
  v_mul_f32 v248, v248, v24
  v_mul_f32 v249, v249, v24
  v_mul_f32 v250, v250, v24
  v_mul_f32 v251, v251, v24
  v_mul_f32 v56, v56, v24
  v_mul_f32 v57, v57, v24
  v_mul_f32 v58, v58, v24
  v_mul_f32 v59, v59, v24
  v_max3_f32 v22, v88, v89, v90
  v_max3_f32 v22, v22, v91, v92
  v_max3_f32 v22, v22, v93, v94
  v_max3_f32 v22, v22, v95, v44
  v_mov_b32 v23, v22
  s_nop 0
  s_nop 0
  v_permlane16_swap_b32 v22, v23
  v_max_f32 v22, v22, v23
  v_mov_b32 v23, v22
  s_nop 0
  s_nop 0
  v_permlane32_swap_b32 v22, v23
  v_max_f32 v22, v22, v23
  v_sub_f32 v24, v44, v22
  v_exp_f32 v24, v24
  v_mov_b32 v44, v22
  v_sub_f32 v88, v88, v22
  v_sub_f32 v89, v89, v22
  v_sub_f32 v90, v90, v22
  v_sub_f32 v91, v91, v22
  v_sub_f32 v92, v92, v22
  v_sub_f32 v93, v93, v22
  v_sub_f32 v94, v94, v22
  v_sub_f32 v95, v95, v22
  v_exp_f32 v88, v88
  v_exp_f32 v89, v89
  v_exp_f32 v90, v90
  v_exp_f32 v91, v91
  v_exp_f32 v92, v92
  v_exp_f32 v93, v93
  v_exp_f32 v94, v94
  v_exp_f32 v95, v95
  v_cvt_pk_bf16_f32 v108, v88, v89
  v_cvt_pk_bf16_f32 v109, v90, v91
  v_cvt_pk_bf16_f32 v110, v92, v93
  v_cvt_pk_bf16_f32 v111, v94, v95
  v_mul_f32 v140, v140, v24
  v_mul_f32 v141, v141, v24
  v_mul_f32 v142, v142, v24
  v_mul_f32 v143, v143, v24
  v_mul_f32 v156, v156, v24
  v_mul_f32 v157, v157, v24
  v_mul_f32 v158, v158, v24
  v_mul_f32 v159, v159, v24
  v_mul_f32 v172, v172, v24
  v_mul_f32 v173, v173, v24
  v_mul_f32 v174, v174, v24
  v_mul_f32 v175, v175, v24
  v_mul_f32 v188, v188, v24
  v_mul_f32 v189, v189, v24
  v_mul_f32 v190, v190, v24
  v_mul_f32 v191, v191, v24
  v_mul_f32 v204, v204, v24
  v_mul_f32 v205, v205, v24
  v_mul_f32 v206, v206, v24
  v_mul_f32 v207, v207, v24
  v_mul_f32 v220, v220, v24
  v_mul_f32 v221, v221, v24
  v_mul_f32 v222, v222, v24
  v_mul_f32 v223, v223, v24
  v_mul_f32 v236, v236, v24
  v_mul_f32 v237, v237, v24
  v_mul_f32 v238, v238, v24
  v_mul_f32 v239, v239, v24
  v_mul_f32 v252, v252, v24
  v_mul_f32 v253, v253, v24
  v_mul_f32 v254, v254, v24
  v_mul_f32 v255, v255, v24
  v_mul_f32 v60, v60, v24
  v_mul_f32 v61, v61, v24
  v_mul_f32 v62, v62, v24
  v_mul_f32 v63, v63, v24
  v_mfma_f32_16x16x32_bf16 v[128:131], a[160:163], v[96:99], v[128:131]
  v_mfma_f32_16x16x32_bf16 v[144:147], a[164:167], v[96:99], v[144:147]
  v_mfma_f32_16x16x32_bf16 v[160:163], a[168:171], v[96:99], v[160:163]
  v_mfma_f32_16x16x32_bf16 v[176:179], a[172:175], v[96:99], v[176:179]
  v_mfma_f32_16x16x32_bf16 v[192:195], a[176:179], v[96:99], v[192:195]
  v_mfma_f32_16x16x32_bf16 v[208:211], a[180:183], v[96:99], v[208:211]
  v_mfma_f32_16x16x32_bf16 v[224:227], a[184:187], v[96:99], v[224:227]
  v_mfma_f32_16x16x32_bf16 v[240:243], a[188:191], v[96:99], v[240:243]
  v_mfma_f32_16x16x32_bf16 v[48:51], a[192:195], v[96:99], v[48:51]
  v_mfma_f32_16x16x32_bf16 v[132:135], a[160:163], v[100:103], v[132:135]
  v_mfma_f32_16x16x32_bf16 v[148:151], a[164:167], v[100:103], v[148:151]
  v_mfma_f32_16x16x32_bf16 v[164:167], a[168:171], v[100:103], v[164:167]
  v_mfma_f32_16x16x32_bf16 v[180:183], a[172:175], v[100:103], v[180:183]
  v_mfma_f32_16x16x32_bf16 v[196:199], a[176:179], v[100:103], v[196:199]
  v_mfma_f32_16x16x32_bf16 v[212:215], a[180:183], v[100:103], v[212:215]
  v_mfma_f32_16x16x32_bf16 v[228:231], a[184:187], v[100:103], v[228:231]
  v_mfma_f32_16x16x32_bf16 v[244:247], a[188:191], v[100:103], v[244:247]
  v_mfma_f32_16x16x32_bf16 v[52:55], a[192:195], v[100:103], v[52:55]
  v_mfma_f32_16x16x32_bf16 v[136:139], a[160:163], v[104:107], v[136:139]
  v_mfma_f32_16x16x32_bf16 v[152:155], a[164:167], v[104:107], v[152:155]
  v_mfma_f32_16x16x32_bf16 v[168:171], a[168:171], v[104:107], v[168:171]
  v_mfma_f32_16x16x32_bf16 v[184:187], a[172:175], v[104:107], v[184:187]
  v_mfma_f32_16x16x32_bf16 v[200:203], a[176:179], v[104:107], v[200:203]
  v_mfma_f32_16x16x32_bf16 v[216:219], a[180:183], v[104:107], v[216:219]
  v_mfma_f32_16x16x32_bf16 v[232:235], a[184:187], v[104:107], v[232:235]
  v_mfma_f32_16x16x32_bf16 v[248:251], a[188:191], v[104:107], v[248:251]
  v_mfma_f32_16x16x32_bf16 v[56:59], a[192:195], v[104:107], v[56:59]
  v_mfma_f32_16x16x32_bf16 v[140:143], a[160:163], v[108:111], v[140:143]
  v_mfma_f32_16x16x32_bf16 v[156:159], a[164:167], v[108:111], v[156:159]
  v_mfma_f32_16x16x32_bf16 v[172:175], a[168:171], v[108:111], v[172:175]
  v_mfma_f32_16x16x32_bf16 v[188:191], a[172:175], v[108:111], v[188:191]
  v_mfma_f32_16x16x32_bf16 v[204:207], a[176:179], v[108:111], v[204:207]
  v_mfma_f32_16x16x32_bf16 v[220:223], a[180:183], v[108:111], v[220:223]
  v_mfma_f32_16x16x32_bf16 v[236:239], a[184:187], v[108:111], v[236:239]
  v_mfma_f32_16x16x32_bf16 v[252:255], a[188:191], v[108:111], v[252:255]
  v_mfma_f32_16x16x32_bf16 v[60:63], a[192:195], v[108:111], v[60:63]
  s_nop 7
  s_nop 1
  ds_read_b128 a[128:131], v2 offset:8192
  ds_read_b128 a[132:135], v3 offset:8192
  ds_read_b128 a[136:139], v4 offset:8192
  ds_read_b128 a[140:143], v5 offset:8192
  ds_read_b128 a[144:147], v2 offset:12288
  ds_read_b128 a[148:151], v3 offset:12288
  ds_read_b128 a[152:155], v4 offset:12288
  ds_read_b128 a[156:159], v5 offset:12288
  ds_read_b64_tr_b16 a[160:161], v6 offset:8192
  ds_read_b64_tr_b16 a[162:163], v6 offset:12288
  ds_read_b64_tr_b16 a[164:165], v7 offset:8192
  ds_read_b64_tr_b16 a[166:167], v7 offset:12288
  ds_read_b64_tr_b16 a[168:169], v8 offset:8192
  ds_read_b64_tr_b16 a[170:171], v8 offset:12288
  ds_read_b64_tr_b16 a[172:173], v9 offset:8192
  ds_read_b64_tr_b16 a[174:175], v9 offset:12288
  ds_read_b64_tr_b16 a[176:177], v10 offset:8192
  ds_read_b64_tr_b16 a[178:179], v10 offset:12288
  ds_read_b64_tr_b16 a[180:181], v11 offset:8192
  ds_read_b64_tr_b16 a[182:183], v11 offset:12288
  ds_read_b64_tr_b16 a[184:185], v12 offset:8192
  ds_read_b64_tr_b16 a[186:187], v12 offset:12288
  ds_read_b64_tr_b16 a[188:189], v13 offset:8192
  ds_read_b64_tr_b16 a[190:191], v13 offset:12288
  s_waitcnt lgkmcnt(0)
  v_mfma_f32_16x16x32_bf16 v[64:67], a[128:131], a[0:3], 0
  v_mfma_f32_16x16x32_bf16 v[64:67], a[132:135], a[16:19], v[64:67]
  v_mfma_f32_16x16x32_bf16 v[64:67], a[136:139], a[32:35], v[64:67]
  v_mfma_f32_16x16x32_bf16 v[64:67], a[140:143], a[48:51], v[64:67]
  v_mfma_f32_16x16x32_bf16 v[68:71], a[144:147], a[0:3], 0
  v_mfma_f32_16x16x32_bf16 v[68:71], a[148:151], a[16:19], v[68:71]
  v_mfma_f32_16x16x32_bf16 v[68:71], a[152:155], a[32:35], v[68:71]
  v_mfma_f32_16x16x32_bf16 v[68:71], a[156:159], a[48:51], v[68:71]
  v_mfma_f32_16x16x32_bf16 v[72:75], a[128:131], a[4:7], 0
  v_mfma_f32_16x16x32_bf16 v[72:75], a[132:135], a[20:23], v[72:75]
  v_mfma_f32_16x16x32_bf16 v[72:75], a[136:139], a[36:39], v[72:75]
  v_mfma_f32_16x16x32_bf16 v[72:75], a[140:143], a[52:55], v[72:75]
  v_mfma_f32_16x16x32_bf16 v[76:79], a[144:147], a[4:7], 0
  v_mfma_f32_16x16x32_bf16 v[76:79], a[148:151], a[20:23], v[76:79]
  v_mfma_f32_16x16x32_bf16 v[76:79], a[152:155], a[36:39], v[76:79]
  v_mfma_f32_16x16x32_bf16 v[76:79], a[156:159], a[52:55], v[76:79]
  v_mfma_f32_16x16x32_bf16 v[80:83], a[128:131], a[8:11], 0
  v_mfma_f32_16x16x32_bf16 v[80:83], a[132:135], a[24:27], v[80:83]
  v_mfma_f32_16x16x32_bf16 v[80:83], a[136:139], a[40:43], v[80:83]
  v_mfma_f32_16x16x32_bf16 v[80:83], a[140:143], a[56:59], v[80:83]
  v_mfma_f32_16x16x32_bf16 v[84:87], a[144:147], a[8:11], 0
  v_mfma_f32_16x16x32_bf16 v[84:87], a[148:151], a[24:27], v[84:87]
  v_mfma_f32_16x16x32_bf16 v[84:87], a[152:155], a[40:43], v[84:87]
  v_mfma_f32_16x16x32_bf16 v[84:87], a[156:159], a[56:59], v[84:87]
  v_mfma_f32_16x16x32_bf16 v[88:91], a[128:131], a[12:15], 0
  v_mfma_f32_16x16x32_bf16 v[88:91], a[132:135], a[28:31], v[88:91]
  v_mfma_f32_16x16x32_bf16 v[88:91], a[136:139], a[44:47], v[88:91]
  v_mfma_f32_16x16x32_bf16 v[88:91], a[140:143], a[60:63], v[88:91]
  v_mfma_f32_16x16x32_bf16 v[92:95], a[144:147], a[12:15], 0
  v_mfma_f32_16x16x32_bf16 v[92:95], a[148:151], a[28:31], v[92:95]
  v_mfma_f32_16x16x32_bf16 v[92:95], a[152:155], a[44:47], v[92:95]
  v_mfma_f32_16x16x32_bf16 v[92:95], a[156:159], a[60:63], v[92:95]
  v_max3_f32 v22, v64, v65, v66
  v_max3_f32 v22, v22, v67, v68
  v_max3_f32 v22, v22, v69, v70
  v_max3_f32 v22, v22, v71, v32
  v_mov_b32 v23, v22
  s_nop 0
  s_nop 0
  v_permlane16_swap_b32 v22, v23
  v_max_f32 v22, v22, v23
  v_mov_b32 v23, v22
  s_nop 0
  s_nop 0
  v_permlane32_swap_b32 v22, v23
  v_max_f32 v22, v22, v23
  v_sub_f32 v24, v32, v22
  v_exp_f32 v24, v24
  v_mov_b32 v32, v22
  v_sub_f32 v64, v64, v22
  v_sub_f32 v65, v65, v22
  v_sub_f32 v66, v66, v22
  v_sub_f32 v67, v67, v22
  v_sub_f32 v68, v68, v22
  v_sub_f32 v69, v69, v22
  v_sub_f32 v70, v70, v22
  v_sub_f32 v71, v71, v22
  v_exp_f32 v64, v64
  v_exp_f32 v65, v65
  v_exp_f32 v66, v66
  v_exp_f32 v67, v67
  v_exp_f32 v68, v68
  v_exp_f32 v69, v69
  v_exp_f32 v70, v70
  v_exp_f32 v71, v71
  v_cvt_pk_bf16_f32 v96, v64, v65
  v_cvt_pk_bf16_f32 v97, v66, v67
  v_cvt_pk_bf16_f32 v98, v68, v69
  v_cvt_pk_bf16_f32 v99, v70, v71
  v_mul_f32 v128, v128, v24
  v_mul_f32 v129, v129, v24
  v_mul_f32 v130, v130, v24
  v_mul_f32 v131, v131, v24
  v_mul_f32 v144, v144, v24
  v_mul_f32 v145, v145, v24
  v_mul_f32 v146, v146, v24
  v_mul_f32 v147, v147, v24
  v_mul_f32 v160, v160, v24
  v_mul_f32 v161, v161, v24
  v_mul_f32 v162, v162, v24
  v_mul_f32 v163, v163, v24
  v_mul_f32 v176, v176, v24
  v_mul_f32 v177, v177, v24
  v_mul_f32 v178, v178, v24
  v_mul_f32 v179, v179, v24
  v_mul_f32 v192, v192, v24
  v_mul_f32 v193, v193, v24
  v_mul_f32 v194, v194, v24
  v_mul_f32 v195, v195, v24
  v_mul_f32 v208, v208, v24
  v_mul_f32 v209, v209, v24
  v_mul_f32 v210, v210, v24
  v_mul_f32 v211, v211, v24
  v_mul_f32 v224, v224, v24
  v_mul_f32 v225, v225, v24
  v_mul_f32 v226, v226, v24
  v_mul_f32 v227, v227, v24
  v_mul_f32 v240, v240, v24
  v_mul_f32 v241, v241, v24
  v_mul_f32 v242, v242, v24
  v_mul_f32 v243, v243, v24
  v_mul_f32 v48, v48, v24
  v_mul_f32 v49, v49, v24
  v_mul_f32 v50, v50, v24
  v_mul_f32 v51, v51, v24
  v_max3_f32 v22, v72, v73, v74
  v_max3_f32 v22, v22, v75, v76
  v_max3_f32 v22, v22, v77, v78
  v_max3_f32 v22, v22, v79, v36
  v_mov_b32 v23, v22
  s_nop 0
  s_nop 0
  v_permlane16_swap_b32 v22, v23
  v_max_f32 v22, v22, v23
  v_mov_b32 v23, v22
  s_nop 0
  s_nop 0
  v_permlane32_swap_b32 v22, v23
  v_max_f32 v22, v22, v23
  v_sub_f32 v24, v36, v22
  v_exp_f32 v24, v24
  v_mov_b32 v36, v22
  v_sub_f32 v72, v72, v22
  v_sub_f32 v73, v73, v22
  v_sub_f32 v74, v74, v22
  v_sub_f32 v75, v75, v22
  v_sub_f32 v76, v76, v22
  v_sub_f32 v77, v77, v22
  v_sub_f32 v78, v78, v22
  v_sub_f32 v79, v79, v22
  v_exp_f32 v72, v72
  v_exp_f32 v73, v73
  v_exp_f32 v74, v74
  v_exp_f32 v75, v75
  v_exp_f32 v76, v76
  v_exp_f32 v77, v77
  v_exp_f32 v78, v78
  v_exp_f32 v79, v79
  v_cvt_pk_bf16_f32 v100, v72, v73
  v_cvt_pk_bf16_f32 v101, v74, v75
  v_cvt_pk_bf16_f32 v102, v76, v77
  v_cvt_pk_bf16_f32 v103, v78, v79
  v_mul_f32 v132, v132, v24
  v_mul_f32 v133, v133, v24
  v_mul_f32 v134, v134, v24
  v_mul_f32 v135, v135, v24
  v_mul_f32 v148, v148, v24
  v_mul_f32 v149, v149, v24
  v_mul_f32 v150, v150, v24
  v_mul_f32 v151, v151, v24
  v_mul_f32 v164, v164, v24
  v_mul_f32 v165, v165, v24
  v_mul_f32 v166, v166, v24
  v_mul_f32 v167, v167, v24
  v_mul_f32 v180, v180, v24
  v_mul_f32 v181, v181, v24
  v_mul_f32 v182, v182, v24
  v_mul_f32 v183, v183, v24
  v_mul_f32 v196, v196, v24
  v_mul_f32 v197, v197, v24
  v_mul_f32 v198, v198, v24
  v_mul_f32 v199, v199, v24
  v_mul_f32 v212, v212, v24
  v_mul_f32 v213, v213, v24
  v_mul_f32 v214, v214, v24
  v_mul_f32 v215, v215, v24
  v_mul_f32 v228, v228, v24
  v_mul_f32 v229, v229, v24
  v_mul_f32 v230, v230, v24
  v_mul_f32 v231, v231, v24
  v_mul_f32 v244, v244, v24
  v_mul_f32 v245, v245, v24
  v_mul_f32 v246, v246, v24
  v_mul_f32 v247, v247, v24
  v_mul_f32 v52, v52, v24
  v_mul_f32 v53, v53, v24
  v_mul_f32 v54, v54, v24
  v_mul_f32 v55, v55, v24
  v_max3_f32 v22, v80, v81, v82
  v_max3_f32 v22, v22, v83, v84
  v_max3_f32 v22, v22, v85, v86
  v_max3_f32 v22, v22, v87, v40
  v_mov_b32 v23, v22
  s_nop 0
  s_nop 0
  v_permlane16_swap_b32 v22, v23
  v_max_f32 v22, v22, v23
  v_mov_b32 v23, v22
  s_nop 0
  s_nop 0
  v_permlane32_swap_b32 v22, v23
  v_max_f32 v22, v22, v23
  v_sub_f32 v24, v40, v22
  v_exp_f32 v24, v24
  v_mov_b32 v40, v22
  v_sub_f32 v80, v80, v22
  v_sub_f32 v81, v81, v22
  v_sub_f32 v82, v82, v22
  v_sub_f32 v83, v83, v22
  v_sub_f32 v84, v84, v22
  v_sub_f32 v85, v85, v22
  v_sub_f32 v86, v86, v22
  v_sub_f32 v87, v87, v22
  v_exp_f32 v80, v80
  v_exp_f32 v81, v81
  v_exp_f32 v82, v82
  v_exp_f32 v83, v83
  v_exp_f32 v84, v84
  v_exp_f32 v85, v85
  v_exp_f32 v86, v86
  v_exp_f32 v87, v87
  v_cvt_pk_bf16_f32 v104, v80, v81
  v_cvt_pk_bf16_f32 v105, v82, v83
  v_cvt_pk_bf16_f32 v106, v84, v85
  v_cvt_pk_bf16_f32 v107, v86, v87
  v_mul_f32 v136, v136, v24
  v_mul_f32 v137, v137, v24
  v_mul_f32 v138, v138, v24
  v_mul_f32 v139, v139, v24
  v_mul_f32 v152, v152, v24
  v_mul_f32 v153, v153, v24
  v_mul_f32 v154, v154, v24
  v_mul_f32 v155, v155, v24
  v_mul_f32 v168, v168, v24
  v_mul_f32 v169, v169, v24
  v_mul_f32 v170, v170, v24
  v_mul_f32 v171, v171, v24
  v_mul_f32 v184, v184, v24
  v_mul_f32 v185, v185, v24
  v_mul_f32 v186, v186, v24
  v_mul_f32 v187, v187, v24
  v_mul_f32 v200, v200, v24
  v_mul_f32 v201, v201, v24
  v_mul_f32 v202, v202, v24
  v_mul_f32 v203, v203, v24
  v_mul_f32 v216, v216, v24
  v_mul_f32 v217, v217, v24
  v_mul_f32 v218, v218, v24
  v_mul_f32 v219, v219, v24
  v_mul_f32 v232, v232, v24
  v_mul_f32 v233, v233, v24
  v_mul_f32 v234, v234, v24
  v_mul_f32 v235, v235, v24
  v_mul_f32 v248, v248, v24
  v_mul_f32 v249, v249, v24
  v_mul_f32 v250, v250, v24
  v_mul_f32 v251, v251, v24
  v_mul_f32 v56, v56, v24
  v_mul_f32 v57, v57, v24
  v_mul_f32 v58, v58, v24
  v_mul_f32 v59, v59, v24
  v_max3_f32 v22, v88, v89, v90
  v_max3_f32 v22, v22, v91, v92
  v_max3_f32 v22, v22, v93, v94
  v_max3_f32 v22, v22, v95, v44
  v_mov_b32 v23, v22
  s_nop 0
  s_nop 0
  v_permlane16_swap_b32 v22, v23
  v_max_f32 v22, v22, v23
  v_mov_b32 v23, v22
  s_nop 0
  s_nop 0
  v_permlane32_swap_b32 v22, v23
  v_max_f32 v22, v22, v23
  v_sub_f32 v24, v44, v22
  v_exp_f32 v24, v24
  v_mov_b32 v44, v22
  v_sub_f32 v88, v88, v22
  v_sub_f32 v89, v89, v22
  v_sub_f32 v90, v90, v22
  v_sub_f32 v91, v91, v22
  v_sub_f32 v92, v92, v22
  v_sub_f32 v93, v93, v22
  v_sub_f32 v94, v94, v22
  v_sub_f32 v95, v95, v22
  v_exp_f32 v88, v88
  v_exp_f32 v89, v89
  v_exp_f32 v90, v90
  v_exp_f32 v91, v91
  v_exp_f32 v92, v92
  v_exp_f32 v93, v93
  v_exp_f32 v94, v94
  v_exp_f32 v95, v95
  v_cvt_pk_bf16_f32 v108, v88, v89
  v_cvt_pk_bf16_f32 v109, v90, v91
  v_cvt_pk_bf16_f32 v110, v92, v93
  v_cvt_pk_bf16_f32 v111, v94, v95
  v_mul_f32 v140, v140, v24
  v_mul_f32 v141, v141, v24
  v_mul_f32 v142, v142, v24
  v_mul_f32 v143, v143, v24
  v_mul_f32 v156, v156, v24
  v_mul_f32 v157, v157, v24
  v_mul_f32 v158, v158, v24
  v_mul_f32 v159, v159, v24
  v_mul_f32 v172, v172, v24
  v_mul_f32 v173, v173, v24
  v_mul_f32 v174, v174, v24
  v_mul_f32 v175, v175, v24
  v_mul_f32 v188, v188, v24
  v_mul_f32 v189, v189, v24
  v_mul_f32 v190, v190, v24
  v_mul_f32 v191, v191, v24
  v_mul_f32 v204, v204, v24
  v_mul_f32 v205, v205, v24
  v_mul_f32 v206, v206, v24
  v_mul_f32 v207, v207, v24
  v_mul_f32 v220, v220, v24
  v_mul_f32 v221, v221, v24
  v_mul_f32 v222, v222, v24
  v_mul_f32 v223, v223, v24
  v_mul_f32 v236, v236, v24
  v_mul_f32 v237, v237, v24
  v_mul_f32 v238, v238, v24
  v_mul_f32 v239, v239, v24
  v_mul_f32 v252, v252, v24
  v_mul_f32 v253, v253, v24
  v_mul_f32 v254, v254, v24
  v_mul_f32 v255, v255, v24
  v_mul_f32 v60, v60, v24
  v_mul_f32 v61, v61, v24
  v_mul_f32 v62, v62, v24
  v_mul_f32 v63, v63, v24
  v_mfma_f32_16x16x32_bf16 v[128:131], a[160:163], v[96:99], v[128:131]
  v_mfma_f32_16x16x32_bf16 v[144:147], a[164:167], v[96:99], v[144:147]
  v_mfma_f32_16x16x32_bf16 v[160:163], a[168:171], v[96:99], v[160:163]
  v_mfma_f32_16x16x32_bf16 v[176:179], a[172:175], v[96:99], v[176:179]
  v_mfma_f32_16x16x32_bf16 v[192:195], a[176:179], v[96:99], v[192:195]
  v_mfma_f32_16x16x32_bf16 v[208:211], a[180:183], v[96:99], v[208:211]
  v_mfma_f32_16x16x32_bf16 v[224:227], a[184:187], v[96:99], v[224:227]
  v_mfma_f32_16x16x32_bf16 v[240:243], a[188:191], v[96:99], v[240:243]
  v_mfma_f32_16x16x32_bf16 v[48:51], a[192:195], v[96:99], v[48:51]
  v_mfma_f32_16x16x32_bf16 v[132:135], a[160:163], v[100:103], v[132:135]
  v_mfma_f32_16x16x32_bf16 v[148:151], a[164:167], v[100:103], v[148:151]
  v_mfma_f32_16x16x32_bf16 v[164:167], a[168:171], v[100:103], v[164:167]
  v_mfma_f32_16x16x32_bf16 v[180:183], a[172:175], v[100:103], v[180:183]
  v_mfma_f32_16x16x32_bf16 v[196:199], a[176:179], v[100:103], v[196:199]
  v_mfma_f32_16x16x32_bf16 v[212:215], a[180:183], v[100:103], v[212:215]
  v_mfma_f32_16x16x32_bf16 v[228:231], a[184:187], v[100:103], v[228:231]
  v_mfma_f32_16x16x32_bf16 v[244:247], a[188:191], v[100:103], v[244:247]
  v_mfma_f32_16x16x32_bf16 v[52:55], a[192:195], v[100:103], v[52:55]
  v_mfma_f32_16x16x32_bf16 v[136:139], a[160:163], v[104:107], v[136:139]
  v_mfma_f32_16x16x32_bf16 v[152:155], a[164:167], v[104:107], v[152:155]
  v_mfma_f32_16x16x32_bf16 v[168:171], a[168:171], v[104:107], v[168:171]
  v_mfma_f32_16x16x32_bf16 v[184:187], a[172:175], v[104:107], v[184:187]
  v_mfma_f32_16x16x32_bf16 v[200:203], a[176:179], v[104:107], v[200:203]
  v_mfma_f32_16x16x32_bf16 v[216:219], a[180:183], v[104:107], v[216:219]
  v_mfma_f32_16x16x32_bf16 v[232:235], a[184:187], v[104:107], v[232:235]
  v_mfma_f32_16x16x32_bf16 v[248:251], a[188:191], v[104:107], v[248:251]
  v_mfma_f32_16x16x32_bf16 v[56:59], a[192:195], v[104:107], v[56:59]
  v_mfma_f32_16x16x32_bf16 v[140:143], a[160:163], v[108:111], v[140:143]
  v_mfma_f32_16x16x32_bf16 v[156:159], a[164:167], v[108:111], v[156:159]
  v_mfma_f32_16x16x32_bf16 v[172:175], a[168:171], v[108:111], v[172:175]
  v_mfma_f32_16x16x32_bf16 v[188:191], a[172:175], v[108:111], v[188:191]
  v_mfma_f32_16x16x32_bf16 v[204:207], a[176:179], v[108:111], v[204:207]
  v_mfma_f32_16x16x32_bf16 v[220:223], a[180:183], v[108:111], v[220:223]
  v_mfma_f32_16x16x32_bf16 v[236:239], a[184:187], v[108:111], v[236:239]
  v_mfma_f32_16x16x32_bf16 v[252:255], a[188:191], v[108:111], v[252:255]
  v_mfma_f32_16x16x32_bf16 v[60:63], a[192:195], v[108:111], v[60:63]
  s_nop 7
  s_nop 1
  s_add_u32 s30, s30, 1
  s_cmp_lt_u32 s30, 16
  s_cbranch_scc1 L_slow_tile
  s_nop 7
  v_mov_b32 v73, 0x4e800000
  v_rcp_f32 v64, v48
  v_rcp_f32 v66, v52
  v_rcp_f32 v68, v56
  v_rcp_f32 v70, v60
  v_mov_b32 v65, v64
  v_mov_b32 v67, v66
  v_mov_b32 v69, v68
  v_mov_b32 v71, v70
  v_pk_mul_f32 v[128:129], v[128:129], v[64:65]
  v_pk_mul_f32 v[130:131], v[130:131], v[64:65]
  v_pk_mul_f32 v[144:145], v[144:145], v[64:65]
  v_pk_mul_f32 v[146:147], v[146:147], v[64:65]
  v_pk_mul_f32 v[132:133], v[132:133], v[66:67]
  v_pk_mul_f32 v[134:135], v[134:135], v[66:67]
  v_pk_mul_f32 v[148:149], v[148:149], v[66:67]
  v_pk_mul_f32 v[150:151], v[150:151], v[66:67]
  v_pk_mul_f32 v[136:137], v[136:137], v[68:69]
  v_pk_mul_f32 v[138:139], v[138:139], v[68:69]
  v_pk_mul_f32 v[152:153], v[152:153], v[68:69]
  v_pk_mul_f32 v[154:155], v[154:155], v[68:69]
  v_pk_mul_f32 v[140:141], v[140:141], v[70:71]
  v_pk_mul_f32 v[142:143], v[142:143], v[70:71]
  v_pk_mul_f32 v[156:157], v[156:157], v[70:71]
  v_pk_mul_f32 v[158:159], v[158:159], v[70:71]
  v_cvt_pk_bf16_f32 v128, v128, v129
  v_cvt_pk_bf16_f32 v129, v130, v131
  v_cvt_pk_bf16_f32 v130, v144, v145
  v_cvt_pk_bf16_f32 v131, v146, v147
  v_cvt_pk_bf16_f32 v132, v132, v133
  v_cvt_pk_bf16_f32 v133, v134, v135
  v_cvt_pk_bf16_f32 v134, v148, v149
  v_cvt_pk_bf16_f32 v135, v150, v151
  v_cvt_pk_bf16_f32 v136, v136, v137
  v_cvt_pk_bf16_f32 v137, v138, v139
  v_cvt_pk_bf16_f32 v138, v152, v153
  v_cvt_pk_bf16_f32 v139, v154, v155
  v_cvt_pk_bf16_f32 v140, v140, v141
  v_cvt_pk_bf16_f32 v141, v142, v143
  v_cvt_pk_bf16_f32 v142, v156, v157
  v_cvt_pk_bf16_f32 v143, v158, v159
  v_pk_mul_f32 v[160:161], v[160:161], v[64:65]
  v_pk_mul_f32 v[162:163], v[162:163], v[64:65]
  v_pk_mul_f32 v[176:177], v[176:177], v[64:65]
  v_pk_mul_f32 v[178:179], v[178:179], v[64:65]
  v_pk_mul_f32 v[164:165], v[164:165], v[66:67]
  v_pk_mul_f32 v[166:167], v[166:167], v[66:67]
  v_pk_mul_f32 v[180:181], v[180:181], v[66:67]
  v_pk_mul_f32 v[182:183], v[182:183], v[66:67]
  v_pk_mul_f32 v[168:169], v[168:169], v[68:69]
  v_pk_mul_f32 v[170:171], v[170:171], v[68:69]
  v_pk_mul_f32 v[184:185], v[184:185], v[68:69]
  v_pk_mul_f32 v[186:187], v[186:187], v[68:69]
  v_pk_mul_f32 v[172:173], v[172:173], v[70:71]
  v_pk_mul_f32 v[174:175], v[174:175], v[70:71]
  v_pk_mul_f32 v[188:189], v[188:189], v[70:71]
  v_pk_mul_f32 v[190:191], v[190:191], v[70:71]
  v_cvt_pk_bf16_f32 v160, v160, v161
  v_cvt_pk_bf16_f32 v161, v162, v163
  v_cvt_pk_bf16_f32 v162, v176, v177
  v_cvt_pk_bf16_f32 v163, v178, v179
  v_cvt_pk_bf16_f32 v164, v164, v165
  v_cvt_pk_bf16_f32 v165, v166, v167
  v_cvt_pk_bf16_f32 v166, v180, v181
  v_cvt_pk_bf16_f32 v167, v182, v183
  v_cvt_pk_bf16_f32 v168, v168, v169
  v_cvt_pk_bf16_f32 v169, v170, v171
  v_cvt_pk_bf16_f32 v170, v184, v185
  v_cvt_pk_bf16_f32 v171, v186, v187
  v_cvt_pk_bf16_f32 v172, v172, v173
  v_cvt_pk_bf16_f32 v173, v174, v175
  v_cvt_pk_bf16_f32 v174, v188, v189
  v_cvt_pk_bf16_f32 v175, v190, v191
  v_pk_mul_f32 v[192:193], v[192:193], v[64:65]
  v_pk_mul_f32 v[194:195], v[194:195], v[64:65]
  v_pk_mul_f32 v[208:209], v[208:209], v[64:65]
  v_pk_mul_f32 v[210:211], v[210:211], v[64:65]
  v_pk_mul_f32 v[196:197], v[196:197], v[66:67]
  v_pk_mul_f32 v[198:199], v[198:199], v[66:67]
  v_pk_mul_f32 v[212:213], v[212:213], v[66:67]
  v_pk_mul_f32 v[214:215], v[214:215], v[66:67]
  v_pk_mul_f32 v[200:201], v[200:201], v[68:69]
  v_pk_mul_f32 v[202:203], v[202:203], v[68:69]
  v_pk_mul_f32 v[216:217], v[216:217], v[68:69]
  v_pk_mul_f32 v[218:219], v[218:219], v[68:69]
  v_pk_mul_f32 v[204:205], v[204:205], v[70:71]
  v_pk_mul_f32 v[206:207], v[206:207], v[70:71]
  v_pk_mul_f32 v[220:221], v[220:221], v[70:71]
  v_pk_mul_f32 v[222:223], v[222:223], v[70:71]
  v_cvt_pk_bf16_f32 v192, v192, v193
  v_cvt_pk_bf16_f32 v193, v194, v195
  v_cvt_pk_bf16_f32 v194, v208, v209
  v_cvt_pk_bf16_f32 v195, v210, v211
  v_cvt_pk_bf16_f32 v196, v196, v197
  v_cvt_pk_bf16_f32 v197, v198, v199
  v_cvt_pk_bf16_f32 v198, v212, v213
  v_cvt_pk_bf16_f32 v199, v214, v215
  v_cvt_pk_bf16_f32 v200, v200, v201
  v_cvt_pk_bf16_f32 v201, v202, v203
  v_cvt_pk_bf16_f32 v202, v216, v217
  v_cvt_pk_bf16_f32 v203, v218, v219
  v_cvt_pk_bf16_f32 v204, v204, v205
  v_cvt_pk_bf16_f32 v205, v206, v207
  v_cvt_pk_bf16_f32 v206, v220, v221
  v_cvt_pk_bf16_f32 v207, v222, v223
  v_pk_mul_f32 v[224:225], v[224:225], v[64:65]
  v_pk_mul_f32 v[226:227], v[226:227], v[64:65]
  v_pk_mul_f32 v[240:241], v[240:241], v[64:65]
  v_pk_mul_f32 v[242:243], v[242:243], v[64:65]
  v_pk_mul_f32 v[228:229], v[228:229], v[66:67]
  v_pk_mul_f32 v[230:231], v[230:231], v[66:67]
  v_pk_mul_f32 v[244:245], v[244:245], v[66:67]
  v_pk_mul_f32 v[246:247], v[246:247], v[66:67]
  v_pk_mul_f32 v[232:233], v[232:233], v[68:69]
  v_pk_mul_f32 v[234:235], v[234:235], v[68:69]
  v_pk_mul_f32 v[248:249], v[248:249], v[68:69]
  v_pk_mul_f32 v[250:251], v[250:251], v[68:69]
  v_pk_mul_f32 v[236:237], v[236:237], v[70:71]
  v_pk_mul_f32 v[238:239], v[238:239], v[70:71]
  v_pk_mul_f32 v[252:253], v[252:253], v[70:71]
  v_pk_mul_f32 v[254:255], v[254:255], v[70:71]
  v_cvt_pk_bf16_f32 v224, v224, v225
  v_cvt_pk_bf16_f32 v225, v226, v227
  v_cvt_pk_bf16_f32 v226, v240, v241
  v_cvt_pk_bf16_f32 v227, v242, v243
  v_cvt_pk_bf16_f32 v228, v228, v229
  v_cvt_pk_bf16_f32 v229, v230, v231
  v_cvt_pk_bf16_f32 v230, v244, v245
  v_cvt_pk_bf16_f32 v231, v246, v247
  v_cvt_pk_bf16_f32 v232, v232, v233
  v_cvt_pk_bf16_f32 v233, v234, v235
  v_cvt_pk_bf16_f32 v234, v248, v249
  v_cvt_pk_bf16_f32 v235, v250, v251
  v_cvt_pk_bf16_f32 v236, v236, v237
  v_cvt_pk_bf16_f32 v237, v238, v239
  v_cvt_pk_bf16_f32 v238, v252, v253
  v_cvt_pk_bf16_f32 v239, v254, v255
  buffer_store_dwordx4 v[128:131], v1, s[20:23], s31 offen offset:0 sc1
  buffer_store_dwordx4 v[132:135], v1, s[20:23], s31 offen offset:1024 sc1
  buffer_store_dwordx4 v[136:139], v1, s[20:23], s31 offen offset:2048 sc1
  buffer_store_dwordx4 v[140:143], v1, s[20:23], s31 offen offset:3072 sc1
  s_add_u32 s31, s31, 0x4000
  buffer_store_dwordx4 v[160:163], v1, s[20:23], s31 offen offset:0 sc1
  buffer_store_dwordx4 v[164:167], v1, s[20:23], s31 offen offset:1024 sc1
  buffer_store_dwordx4 v[168:171], v1, s[20:23], s31 offen offset:2048 sc1
  buffer_store_dwordx4 v[172:175], v1, s[20:23], s31 offen offset:3072 sc1
  s_add_u32 s31, s31, 0x4000
  buffer_store_dwordx4 v[192:195], v1, s[20:23], s31 offen offset:0 sc1
  buffer_store_dwordx4 v[196:199], v1, s[20:23], s31 offen offset:1024 sc1
  buffer_store_dwordx4 v[200:203], v1, s[20:23], s31 offen offset:2048 sc1
  buffer_store_dwordx4 v[204:207], v1, s[20:23], s31 offen offset:3072 sc1
  s_add_u32 s31, s31, 0x4000
  buffer_store_dwordx4 v[224:227], v1, s[20:23], s31 offen offset:0 sc1
  buffer_store_dwordx4 v[228:231], v1, s[20:23], s31 offen offset:1024 sc1
  buffer_store_dwordx4 v[232:235], v1, s[20:23], s31 offen offset:2048 sc1
  buffer_store_dwordx4 v[236:239], v1, s[20:23], s31 offen offset:3072 sc1
  s_add_u32 s31, s31, 0x4000
  s_add_u32 s54, s54, 1
  s_cmp_lt_u32 s54, 2
  s_cbranch_scc0 L_slow_done
  s_nop 4
  v_accvgpr_mov_b32 a0, a64
  v_accvgpr_mov_b32 a1, a65
  v_accvgpr_mov_b32 a2, a66
  v_accvgpr_mov_b32 a3, a67
  v_accvgpr_mov_b32 a4, a68
  v_accvgpr_mov_b32 a5, a69
  v_accvgpr_mov_b32 a6, a70
  v_accvgpr_mov_b32 a7, a71
  v_accvgpr_mov_b32 a8, a72
  v_accvgpr_mov_b32 a9, a73
  v_accvgpr_mov_b32 a10, a74
  v_accvgpr_mov_b32 a11, a75
  v_accvgpr_mov_b32 a12, a76
  v_accvgpr_mov_b32 a13, a77
  v_accvgpr_mov_b32 a14, a78
  v_accvgpr_mov_b32 a15, a79
  v_accvgpr_mov_b32 a16, a80
  v_accvgpr_mov_b32 a17, a81
  v_accvgpr_mov_b32 a18, a82
  v_accvgpr_mov_b32 a19, a83
  v_accvgpr_mov_b32 a20, a84
  v_accvgpr_mov_b32 a21, a85
  v_accvgpr_mov_b32 a22, a86
  v_accvgpr_mov_b32 a23, a87
  v_accvgpr_mov_b32 a24, a88
  v_accvgpr_mov_b32 a25, a89
  v_accvgpr_mov_b32 a26, a90
  v_accvgpr_mov_b32 a27, a91
  v_accvgpr_mov_b32 a28, a92
  v_accvgpr_mov_b32 a29, a93
  v_accvgpr_mov_b32 a30, a94
  v_accvgpr_mov_b32 a31, a95
  v_accvgpr_mov_b32 a32, a96
  v_accvgpr_mov_b32 a33, a97
  v_accvgpr_mov_b32 a34, a98
  v_accvgpr_mov_b32 a35, a99
  v_accvgpr_mov_b32 a36, a100
  v_accvgpr_mov_b32 a37, a101
  v_accvgpr_mov_b32 a38, a102
  v_accvgpr_mov_b32 a39, a103
  v_accvgpr_mov_b32 a40, a104
  v_accvgpr_mov_b32 a41, a105
  v_accvgpr_mov_b32 a42, a106
  v_accvgpr_mov_b32 a43, a107
  v_accvgpr_mov_b32 a44, a108
  v_accvgpr_mov_b32 a45, a109
  v_accvgpr_mov_b32 a46, a110
  v_accvgpr_mov_b32 a47, a111
  v_accvgpr_mov_b32 a48, a112
  v_accvgpr_mov_b32 a49, a113
  v_accvgpr_mov_b32 a50, a114
  v_accvgpr_mov_b32 a51, a115
  v_accvgpr_mov_b32 a52, a116
  v_accvgpr_mov_b32 a53, a117
  v_accvgpr_mov_b32 a54, a118
  v_accvgpr_mov_b32 a55, a119
  v_accvgpr_mov_b32 a56, a120
  v_accvgpr_mov_b32 a57, a121
  v_accvgpr_mov_b32 a58, a122
  v_accvgpr_mov_b32 a59, a123
  v_accvgpr_mov_b32 a60, a124
  v_accvgpr_mov_b32 a61, a125
  v_accvgpr_mov_b32 a62, a126
  v_accvgpr_mov_b32 a63, a127
  s_branch L_slow_head
L_slow_done:
  s_waitcnt vmcnt(0) lgkmcnt(0)
  s_barrier
  s_sub_u32 s55, 0x10001, s3
  s_cmp_lg_u32 s24, 0
  s_cbranch_scc1 L_sig_slow
  s_mov_b64 exec, 1
  v_mov_b32 v76, s55
  v_mov_b32 v77, s95
  buffer_atomic_add v76, v77, s[76:79], 0 offen sc1
  s_mov_b64 exec, -1
L_sig_slow:
  s_cmp_lg_u32 s24, 0
  s_cbranch_scc1 L_f1s_ok
L_f1s_spin:
  s_sleep 16
  buffer_load_dwordx4 v[24:27], off, s[76:79], s92 sc1
  s_waitcnt vmcnt(0)
  v_and_b32 v24, v24, v25
  v_and_b32 v26, v26, v27
  v_and_b32 v24, v24, v26
  s_nop 0
  v_readfirstlane_b32 s48, v24
  s_bitcmp1_b32 s48, 2
  s_cbranch_scc0 L_f1s_spin
L_f1s_ok:
  s_barrier
  v_mbcnt_lo_u32_b32 v20, -1, 0
  v_mbcnt_hi_u32_b32 v20, -1, v20
  v_and_b32 v21, 15, v20
  v_lshrrev_b32 v22, 4, v20
  v_lshrrev_b32 v23, 2, v21
  v_and_b32 v24, 3, v20
  v_lshl_add_u32 v26, v22, 2, v23
  v_lshrrev_b32 v27, 1, v26
  v_and_b32 v27, 3, v27
  v_lshlrev_b32 v26, 7, v26
  v_lshl_add_u32 v26, v24, 3, v26
  v_add_u32 v26, s91, v26
  v_xor_b32 v25, 0, v27
  v_lshl_add_u32 v96, v25, 5, v26
  v_xor_b32 v25, 1, v27
  v_lshl_add_u32 v97, v25, 5, v26
  v_xor_b32 v25, 2, v27
  v_lshl_add_u32 v98, v25, 5, v26
  v_xor_b32 v25, 3, v27
  v_lshl_add_u32 v99, v25, 5, v26
  v_lshlrev_b32 v25, 1, v22
  v_and_b32 v26, 7, v20
  v_xor_b32 v25, v25, v26
  v_lshlrev_b32 v25, 4, v25
  v_lshrrev_b32 v26, 3, v20
  v_lshl_add_u32 v25, v26, 10, v25
  v_add_u32 v100, 0, v25
  v_add_u32 v101, 7168, v25
  v_add_u32 v102, 14336, v25
  v_add_u32 v103, 21504, v25
  v_add_u32 v104, 0x1000, v1
  v_lshlrev_b32 v106, 10, v21
  v_lshl_add_u32 v106, v22, 3, v106
  s_lshl_b32 s88, s24, 5
  s_add_u32 s88, s88, 0
  s_lshl_b32 s89, s88, 15
  s_lshl_b32 s90, s88, 14
  s_add_u32 s90, s90, s93
  buffer_load_dwordx4 a[64:67], v1, s[20:23], s90 offen offset:0 sc1
  buffer_load_dwordx4 a[68:71], v1, s[20:23], s90 offen offset:1024 sc1
  buffer_load_dwordx4 a[72:75], v1, s[20:23], s90 offen offset:2048 sc1
  buffer_load_dwordx4 a[76:79], v1, s[20:23], s90 offen offset:3072 sc1
  buffer_load_dwordx4 a[80:83], v104, s[20:23], s90 offen offset:0 sc1
  buffer_load_dwordx4 a[84:87], v104, s[20:23], s90 offen offset:1024 sc1
  buffer_load_dwordx4 a[88:91], v104, s[20:23], s90 offen offset:2048 sc1
  buffer_load_dwordx4 a[92:95], v104, s[20:23], s90 offen offset:3072 sc1
  s_add_u32 m0, s91, 0x0
  s_nop 0
  buffer_load_dwordx4 v100, s[80:83], s89 offen offset:0 lds
  buffer_load_dwordx4 v101, s[80:83], s89 offen offset:1024 lds
  buffer_load_dwordx4 v102, s[80:83], s89 offen offset:2048 lds
  buffer_load_dwordx4 v103, s[80:83], s89 offen offset:3072 lds
  s_add_u32 s88, s88, 1
  s_lshl_b32 s89, s88, 15
  s_lshl_b32 s90, s88, 14
  s_add_u32 s90, s90, s93
  buffer_load_dwordx4 a[96:99], v1, s[20:23], s90 offen offset:0 sc1
  buffer_load_dwordx4 a[100:103], v1, s[20:23], s90 offen offset:1024 sc1
  buffer_load_dwordx4 a[104:107], v1, s[20:23], s90 offen offset:2048 sc1
  buffer_load_dwordx4 a[108:111], v1, s[20:23], s90 offen offset:3072 sc1
  buffer_load_dwordx4 a[112:115], v104, s[20:23], s90 offen offset:0 sc1
  buffer_load_dwordx4 a[116:119], v104, s[20:23], s90 offen offset:1024 sc1
  buffer_load_dwordx4 a[120:123], v104, s[20:23], s90 offen offset:2048 sc1
  buffer_load_dwordx4 a[124:127], v104, s[20:23], s90 offen offset:3072 sc1
  s_add_u32 m0, s91, 0x1000
  s_nop 0
  buffer_load_dwordx4 v100, s[80:83], s89 offen offset:0 lds
  buffer_load_dwordx4 v101, s[80:83], s89 offen offset:1024 lds
  buffer_load_dwordx4 v102, s[80:83], s89 offen offset:2048 lds
  buffer_load_dwordx4 v103, s[80:83], s89 offen offset:3072 lds
  s_add_u32 s88, s88, 1
  s_lshl_b32 s89, s88, 15
  s_lshl_b32 s90, s88, 14
  s_add_u32 s90, s90, s93
  buffer_load_dwordx4 a[0:3], v1, s[20:23], s90 offen offset:0 sc1
  buffer_load_dwordx4 a[4:7], v1, s[20:23], s90 offen offset:1024 sc1
  buffer_load_dwordx4 a[8:11], v1, s[20:23], s90 offen offset:2048 sc1
  buffer_load_dwordx4 a[12:15], v1, s[20:23], s90 offen offset:3072 sc1
  buffer_load_dwordx4 a[16:19], v104, s[20:23], s90 offen offset:0 sc1
  buffer_load_dwordx4 a[20:23], v104, s[20:23], s90 offen offset:1024 sc1
  buffer_load_dwordx4 a[24:27], v104, s[20:23], s90 offen offset:2048 sc1
  buffer_load_dwordx4 a[28:31], v104, s[20:23], s90 offen offset:3072 sc1
  s_add_u32 m0, s91, 0x2000
  s_nop 0
  buffer_load_dwordx4 v100, s[80:83], s89 offen offset:0 lds
  buffer_load_dwordx4 v101, s[80:83], s89 offen offset:1024 lds
  buffer_load_dwordx4 v102, s[80:83], s89 offen offset:2048 lds
  buffer_load_dwordx4 v103, s[80:83], s89 offen offset:3072 lds
  s_add_u32 s88, s88, 1
  s_lshl_b32 s89, s88, 15
  s_lshl_b32 s90, s88, 14
  s_add_u32 s90, s90, s93
  buffer_load_dwordx4 a[32:35], v1, s[20:23], s90 offen offset:0 sc1
  buffer_load_dwordx4 a[36:39], v1, s[20:23], s90 offen offset:1024 sc1
  buffer_load_dwordx4 a[40:43], v1, s[20:23], s90 offen offset:2048 sc1
  buffer_load_dwordx4 a[44:47], v1, s[20:23], s90 offen offset:3072 sc1
  buffer_load_dwordx4 a[48:51], v104, s[20:23], s90 offen offset:0 sc1
  buffer_load_dwordx4 a[52:55], v104, s[20:23], s90 offen offset:1024 sc1
  buffer_load_dwordx4 a[56:59], v104, s[20:23], s90 offen offset:2048 sc1
  buffer_load_dwordx4 a[60:63], v104, s[20:23], s90 offen offset:3072 sc1
  s_add_u32 m0, s91, 0x3000
  s_nop 0
  buffer_load_dwordx4 v100, s[80:83], s89 offen offset:0 lds
  buffer_load_dwordx4 v101, s[80:83], s89 offen offset:1024 lds
  buffer_load_dwordx4 v102, s[80:83], s89 offen offset:2048 lds
  buffer_load_dwordx4 v103, s[80:83], s89 offen offset:3072 lds
  s_add_u32 s88, s88, 5
  s_lshl_b32 s89, s88, 15
  s_lshl_b32 s90, s88, 14
  s_add_u32 s90, s90, s93
  buffer_load_dwordx4 a[128:131], v1, s[20:23], s90 offen offset:0 sc1
  buffer_load_dwordx4 a[132:135], v1, s[20:23], s90 offen offset:1024 sc1
  buffer_load_dwordx4 a[136:139], v1, s[20:23], s90 offen offset:2048 sc1
  buffer_load_dwordx4 a[140:143], v1, s[20:23], s90 offen offset:3072 sc1
  buffer_load_dwordx4 a[144:147], v104, s[20:23], s90 offen offset:0 sc1
  buffer_load_dwordx4 a[148:151], v104, s[20:23], s90 offen offset:1024 sc1
  buffer_load_dwordx4 a[152:155], v104, s[20:23], s90 offen offset:2048 sc1
  buffer_load_dwordx4 a[156:159], v104, s[20:23], s90 offen offset:3072 sc1
  s_add_u32 m0, s91, 0x4000
  s_nop 0
  buffer_load_dwordx4 v100, s[80:83], s89 offen offset:0 lds
  buffer_load_dwordx4 v101, s[80:83], s89 offen offset:1024 lds
  buffer_load_dwordx4 v102, s[80:83], s89 offen offset:2048 lds
  buffer_load_dwordx4 v103, s[80:83], s89 offen offset:3072 lds
  s_add_u32 s88, s88, 1
  s_lshl_b32 s89, s88, 15
  s_lshl_b32 s90, s88, 14
  s_add_u32 s90, s90, s93
  v_mov_b32 v84, 0
  v_mov_b32 v85, 0
  v_mov_b32 v86, 0
  v_mov_b32 v87, 0
  s_waitcnt vmcnt(0)
  s_mov_b32 s69, 2
  s_branch L_oproj
.section .rodata,"a"
.p2align 6
.amdhsa_kernel standalone__mha_block_cached__near_ridge_kernel
  .amdhsa_next_free_vgpr 512
  .amdhsa_next_free_sgpr 102
  .amdhsa_accum_offset 256
  .amdhsa_group_segment_fixed_size 0
  .amdhsa_kernarg_size 64
  .amdhsa_user_sgpr_count 2
  .amdhsa_user_sgpr_kernarg_segment_ptr 1
  .amdhsa_system_sgpr_workgroup_id_x 1
.end_amdhsa_kernel
```
